```python
import torch

def _softmax(x, axis=-1):
    return torch.softmax(x, dim=axis)

def _gelu(x):
    return torch.nn.functional.gelu(x, approximate='tanh')

def _silu(x):
    return torch.nn.functional.silu(x)

def _sigmoid(x):
    return torch.sigmoid(x)

def _layernorm(x, axis=-1, eps=1e-05):
    m = x.mean(dim=axis, keepdim=True)
    v = x.var(dim=axis, keepdim=True, unbiased=False)
    return (x - m) / torch.sqrt(v + eps)

def _scatter_add(tgt, idx, src, axis=0):
    return tgt.clone().index_add_(axis, idx, src)

def _segment_sum(src, seg, n):
    out = torch.zeros((n,) + src.shape[1:], dtype=src.dtype)
    return out.index_add_(0, seg, src)

def _pad(x, pw):
    flat = tuple((v for pair in reversed(pw) for v in pair))
    return torch.nn.functional.pad(x, flat)
kernel_name = 'sequential_preLN__ssm_conv_h3__mixer_gmlp__prompt'

def setup_inputs():

    _w = lambda a: (lambda t: t.to(torch.bfloat16) if t.is_floating_point() else t)(torch.as_tensor(a))

    def _A_setup():
        B, S, D = (1, 2048, 512)
        ks = 4
        return {'q': _w((lambda *s: torch.randn(*s, dtype=torch.bfloat16) * 0.05)(B, S, D)), 'k': _w((lambda *s: torch.randn(*s, dtype=torch.bfloat16) * 0.4)(B, S, D)), 'v': _w((lambda *s: torch.randn(*s, dtype=torch.bfloat16) * 0.4)(B, S, D)), 'shift_k': _w((lambda *s: torch.randn(*s, dtype=torch.bfloat16) * 0.4)(D, ks) * 0.5), 'ssm_k': _w((lambda *s: torch.randn(*s, dtype=torch.bfloat16) * 0.4)(D, S) * (1.0 / S ** 0.5)), 'ssm_D': _w((lambda *s: torch.randn(*s, dtype=torch.bfloat16) * 0.4)(D))}
    _A_in = _A_setup()

    def _B_setup():
        B, S, D, F = (1, 2048, 512, 1792)
        Fh = F // 2
        return {'x': _w((lambda *s: torch.randn(*s, dtype=torch.bfloat16) * 0.05)(B, S, D)), 'w_in': _w((lambda *s: torch.randn(*s, dtype=torch.bfloat16) * 0.4)(D, 2 * Fh)), 'w_sp': _w(0.01 * (lambda *s: torch.randn(*s, dtype=torch.bfloat16) * 0.4)(S, S)), 'b_sp': _w(1.0 + 0.01 * (lambda *s: torch.randn(*s, dtype=torch.bfloat16) * 0.05)(S)), 'w_out': _w((lambda *s: torch.randn(*s, dtype=torch.bfloat16) * 0.05)(Fh, D))}
    _B_in = _B_setup()
    return {'A_q': _A_in['q'], 'A_k': _A_in['k'], 'A_v': _A_in['v'], 'A_shift_k': _A_in['shift_k'], 'A_ssm_k': _A_in['ssm_k'], 'A_ssm_D': _A_in['ssm_D'], 'B_x': _B_in['x'], 'B_w_in': _B_in['w_in'], 'B_w_sp': _B_in['w_sp'], 'B_b_sp': _B_in['b_sp'], 'B_w_out': _B_in['w_out']}

def reference(A_q, A_k, A_v, A_shift_k, A_ssm_k, A_ssm_D, B_x, B_w_in, B_w_sp, B_b_sp, B_w_out):

    def _A_ref(q, k, v, shift_k, ssm_k, ssm_D):
        B, S, D = q.shape
        ks = shift_k.shape[-1]
        k_pad = _pad(k, ((0, 0), (ks - 1, 0), (0, 0)))
        k_shift = torch.zeros_like(k)
        for t in range(ks):
            k_shift = k_shift + k_pad[:, t:t + S, :] * shift_k[:, ks - 1 - t][None, None, :]
        kv = k_shift * v
        L = 2 * S
        kv_pad = _pad(kv, ((0, 0), (0, S), (0, 0)))
        kf_pad = _pad(ssm_k, ((0, 0), (0, S)))
        kv_f = (lambda x, axes=(-2, -1): torch.fft.rfft2(x.float(), dim=axes))(kv_pad[:, None, :, :], axes=(1, 2))
        kf_f = (lambda x, axes=(-2, -1): torch.fft.rfft2(x.float(), dim=axes))(kf_pad[:, None, :], axes=(1, 2))
        kf_f = (lambda x, *d: x.permute(*d))(kf_f, 1, 2, 0)
        y_f = kv_f * kf_f[None, :, :, :]
        y = (lambda x, s, axes=(-2, -1): torch.fft.irfft2(x, s=s, dim=axes).to(torch.bfloat16))(y_f, (1, L), axes=(1, 2))[:, 0, :S, :]
        y = y + kv * ssm_D[None, None, :]
        return q * y

    def _B_ref(x, w_in, w_sp, b_sp, w_out):
        B, S, D = x.shape
        F = w_in.shape[-1]
        Fh = F // 2
        z = _gelu(torch.einsum('bsd,df->bsf', x, w_in))
        z1 = z[..., :Fh].clone()
        z2 = _layernorm(z[..., Fh:], axis=-1)
        g = torch.einsum('ts,bsf->btf', w_sp, z2) + b_sp[None, :, None]
        return torch.einsum('bsf,fd->bsd', z1 * g, w_out)
    x = A_q
    h = x + _A_ref(_layernorm(x, axis=-1), A_k, A_v, A_shift_k, A_ssm_k, A_ssm_D)
    h2 = h + _B_ref(_layernorm(h, axis=-1), B_w_in, B_w_sp, B_b_sp, B_w_out)
    return h2
```

```asm
; @launch grid=(256,1,1) block=(256,1,1) lds=163840
.amdgcn_target "amdgcn-amd-amdhsa--gfx950"
.text
.globl sequential_preLN__ssm_conv_h3__mixer_gmlp__prompt_kernel
.p2align 8
.type sequential_preLN__ssm_conv_h3__mixer_gmlp__prompt_kernel,@function
sequential_preLN__ssm_conv_h3__mixer_gmlp__prompt_kernel:
    s_cmp_ge_u32 s2, 256
    s_cbranch_scc1 KEND
    s_load_dwordx8 s[4:11], s[0:1], 0
    s_load_dwordx4 s[12:15], s[0:1], 32
    s_load_dwordx8 s[16:23], s[0:1], 56
    s_load_dwordx4 s[24:27], s[0:1], 88
    s_load_dwordx2 s[28:29], s[0:1], 104
    v_and_b32 v1, 63, v0
    v_lshrrev_b32 v29, 6, v0
    v_and_b32 v27, 15, v1
    v_readfirstlane_b32 s3, v29
    v_lshrrev_b32 v28, 4, v1
    s_and_b32 s30, s2, 7
    s_lshr_b32 s31, s2, 3
    s_lshr_b32 s48, s30, 1
    s_lshl_b32 s48, s48, 3
    s_and_b32 s50, s31, 7
    s_add_u32 s48, s48, s50
    s_and_b32 s49, s30, 1
    s_lshl_b32 s49, s49, 2
    s_lshr_b32 s50, s31, 3
    s_add_u32 s49, s49, s50
    s_and_b32 s64, s48, 7
    s_lshl_b32 s64, s64, 1
    s_lshl_b32 s65, s49, 1
    s_add_u32 s65, s65, s48
    s_mul_i32 s50, s65, 9363
    s_lshr_b32 s50, s50, 16
    s_mul_i32 s50, s50, 7
    s_sub_u32 s65, s65, s50
    s_mov_b32 s68, 0
    s_mov_b32 s64, 0
    s_mov_b32 s65, 0
    s_waitcnt lgkmcnt(0)
    s_mov_b32 s32, s28
    s_mov_b32 s33, s29
    s_mov_b32 s34, 0x1600000
    s_mov_b32 s35, 0x20000
    s_lshl_b32 s50, s30, 6
    s_lshl_b32 s51, s31, 1
    s_add_u32 s50, s50, s51
    s_lshl_b32 s50, s50, 1
    s_load_dword s56, s[14:15], s50
    s_cmp_eq_u32 s2, 0
    s_cbranch_scc0 boot_1
    s_cmp_eq_u32 s3, 3
    s_cbranch_scc0 boot_1
    v_lshlrev_b32 v29, 8, v1
    v_add_u32 v29, 0x1550000, v29
    v_mov_b32 v30, 0
    global_store_dword v29, v30, s[28:29] sc1
    v_add_u32 v29, 0x4000, v29
    global_store_dword v29, v30, s[28:29] sc1
    v_add_u32 v29, 0x4000, v29
    global_store_dword v29, v30, s[28:29] sc1
    v_add_u32 v29, 0x4000, v29
    global_store_dword v29, v30, s[28:29] sc1
boot_1:
    v_and_b32 v92, 7, v0
    v_lshrrev_b32 v93, 3, v0
    s_lshl_b32 s50, s31, 16
    s_lshl_b32 s51, s30, 7
    s_add_u32 s50, s50, s51
    v_lshlrev_b32 v94, 11, v93
    v_lshl_add_u32 v94, v92, 4, v94
    v_add_u32 v94, s50, v94
    s_mov_b32 s36, s10
    s_mov_b32 s37, s11
    s_mov_b32 s38, 0x1000
    s_mov_b32 s39, 0x20000
    s_lshl_b32 s50, s30, 9
    v_lshlrev_b32 v98, 6, v92
    v_add_u32 v98, s50, v98
    s_mov_b32 s40, s6
    s_mov_b32 s41, s7
    s_mov_b32 s42, 0x200000
    s_mov_b32 s43, 0x20000
    s_mov_b32 s44, s8
    s_mov_b32 s45, s9
    s_mov_b32 s46, 0x200000
    s_mov_b32 s47, 0x20000
    v_subrev_u32 v95, 3072, v94
    v_subrev_u32 v96, 2048, v94
    v_subrev_u32 v97, 1024, v94
    buffer_load_dwordx4 v[44:47], v94, s[40:43], 0 offen offset:0
    buffer_load_dwordx4 v[48:51], v94, s[40:43], 0 offen offset:1024
    buffer_load_dwordx4 v[52:55], v94, s[44:47], 0 offen offset:0
    buffer_load_dwordx4 v[56:59], v94, s[44:47], 0 offen offset:1024
    buffer_load_dwordx4 v[32:35], v95, s[40:43], 0 offen offset:0
    buffer_load_dwordx4 v[36:39], v96, s[40:43], 0 offen offset:0
    buffer_load_dwordx4 v[40:43], v97, s[40:43], 0 offen offset:0
    buffer_load_dwordx4 v[68:71], v98, s[36:39], 0 offen offset:0
    buffer_load_dwordx4 v[72:75], v98, s[36:39], 0 offen offset:16
    buffer_load_dwordx4 v[76:79], v98, s[36:39], 0 offen offset:32
    buffer_load_dwordx4 v[80:83], v98, s[36:39], 0 offen offset:48
    v_lshlrev_b32 v99, 4, v1
    s_mov_b32 s44, s4
    s_mov_b32 s45, s5
    s_mov_b32 s46, 0x200000
    s_mov_b32 s47, 0x20000
    buffer_load_dwordx4 v[60:63], v94, s[44:47], 0 offen offset:0
    buffer_load_dwordx4 v[64:67], v94, s[44:47], 0 offen offset:1024
    s_lshl_b32 s50, s2, 3
    s_lshl_b32 s51, s3, 1
    s_add_u32 s50, s50, s51
    s_lshl_b32 s50, s50, 10
    buffer_load_dwordx4 v[84:87], v99, s[44:47], s50 offen offset:0
    buffer_load_dwordx4 v[88:91], v99, s[44:47], s50 offen offset:1024
    s_mov_b32 s36, s16
    s_mov_b32 s37, s17
    s_mov_b32 s38, 0x1c0000
    s_mov_b32 s39, 0x20000
    s_and_b32 s50, s2, 15
    s_mul_i32 s50, s50, 114688
    s_lshr_b32 s51, s2, 4
    s_mul_i32 s51, s51, 224
    s_add_u32 s54, s50, s51
    s_add_u32 s50, s3, 0
    s_lshl_b32 s51, s50, 6
    v_add_u32 v240, s51, v1
    v_mul_u32_u24 v241, 4682, v240
    v_lshrrev_b32 v241, 16, v241
    v_mul_u32_u24 v242, 14, v241
    v_sub_u32 v242, v240, v242
    v_mul_u32_u24 v241, 3584, v241
    v_lshl_add_u32 v241, v242, 4, v241
    v_cmp_gt_u32 vcc, 448, v240
    v_mov_b32 v242, 0x40000000
    s_lshl_b32 s51, s50, 10
    v_cndmask_b32 v243, v242, v241, vcc
    s_cmp_eq_u32 s50, 7
    s_cselect_b32 s51, 0x3000, s51
    s_add_u32 m0, s51, 0x14800
    s_nop 0
    buffer_load_dwordx4 v243, s[36:39], s54 offen lds
    s_add_u32 s50, s3, 4
    s_lshl_b32 s51, s50, 6
    v_add_u32 v240, s51, v1
    v_mul_u32_u24 v241, 4682, v240
    v_lshrrev_b32 v241, 16, v241
    v_mul_u32_u24 v242, 14, v241
    v_sub_u32 v242, v240, v242
    v_mul_u32_u24 v241, 3584, v241
    v_lshl_add_u32 v241, v242, 4, v241
    v_cmp_gt_u32 vcc, 448, v240
    v_mov_b32 v242, 0x40000000
    s_lshl_b32 s51, s50, 10
    v_cndmask_b32 v244, v242, v241, vcc
    s_cmp_eq_u32 s50, 7
    s_cselect_b32 s51, 0x3000, s51
    s_add_u32 m0, s51, 0x14800
    s_nop 0
    buffer_load_dwordx4 v244, s[36:39], s54 offen lds
    s_mov_b32 s40, s22
    s_mov_b32 s41, s23
    s_mov_b32 s42, 0xe0000
    s_mov_b32 s43, 0x20000
    s_mul_i32 s50, s2, 2341
    s_lshr_b32 s50, s50, 16
    s_mul_i32 s51, s50, 28
    s_sub_u32 s51, s2, s51
    s_lshl_b32 s52, s51, 15
    s_lshl_b32 s53, s50, 7
    s_add_u32 s52, s52, s53
    s_lshl_b32 s53, s3, 13
    s_add_u32 s52, s52, s53
    s_cmp_ge_u32 s2, 224
    s_cselect_b32 s52, 0x40000000, s52
    v_lshrrev_b32 v240, 3, v1
    v_lshlrev_b32 v240, 10, v240
    v_and_b32 v241, 7, v1
    v_lshlrev_b32 v242, 1, v28
    v_xor_b32 v241, v241, v242
    v_lshl_add_u32 v240, v241, 4, v240
    s_lshl_b32 s53, s3, 10
    s_add_u32 m0, s53, 0x16400
    s_nop 0
    buffer_load_dwordx4 v240, s[40:43], s52 offen lds
    s_cmp_eq_u32 s2, 0
    s_cbranch_scc0 boot_2
    s_cmp_eq_u32 s3, 3
    s_cbranch_scc0 boot_2
    s_waitcnt vmcnt(18)
    v_mov_b32 v29, 0
    v_mov_b32 v30, 1
    s_mov_b64 s[52:53], exec
    s_mov_b64 exec, 1
    global_store_dword v29, v30, s[26:27] sc1
    s_mov_b64 exec, s[52:53]
boot_2:
    s_waitcnt vmcnt(7)
    v_lshlrev_b32 v104, 16, v32
    v_and_b32 v105, 0xffff0000, v32
    v_lshlrev_b32 v106, 16, v33
    v_and_b32 v107, 0xffff0000, v33
    v_lshlrev_b32 v108, 16, v34
    v_and_b32 v109, 0xffff0000, v34
    v_lshlrev_b32 v110, 16, v35
    v_and_b32 v111, 0xffff0000, v35
    v_lshlrev_b32 v112, 16, v36
    v_and_b32 v113, 0xffff0000, v36
    v_lshlrev_b32 v114, 16, v37
    v_and_b32 v115, 0xffff0000, v37
    v_lshlrev_b32 v116, 16, v38
    v_and_b32 v117, 0xffff0000, v38
    v_lshlrev_b32 v118, 16, v39
    v_and_b32 v119, 0xffff0000, v39
    v_lshlrev_b32 v120, 16, v40
    v_and_b32 v121, 0xffff0000, v40
    v_lshlrev_b32 v122, 16, v41
    v_and_b32 v123, 0xffff0000, v41
    v_lshlrev_b32 v124, 16, v42
    v_and_b32 v125, 0xffff0000, v42
    v_lshlrev_b32 v126, 16, v43
    v_and_b32 v127, 0xffff0000, v43
    v_lshlrev_b32 v128, 16, v44
    v_and_b32 v129, 0xffff0000, v44
    v_lshlrev_b32 v130, 16, v45
    v_and_b32 v131, 0xffff0000, v45
    v_lshlrev_b32 v132, 16, v46
    v_and_b32 v133, 0xffff0000, v46
    v_lshlrev_b32 v134, 16, v47
    v_and_b32 v135, 0xffff0000, v47
    v_lshlrev_b32 v136, 16, v48
    v_and_b32 v137, 0xffff0000, v48
    v_lshlrev_b32 v138, 16, v49
    v_and_b32 v139, 0xffff0000, v49
    v_lshlrev_b32 v140, 16, v50
    v_and_b32 v141, 0xffff0000, v50
    v_lshlrev_b32 v142, 16, v51
    v_and_b32 v143, 0xffff0000, v51
    v_lshlrev_b32 v144, 16, v68
    v_and_b32 v152, 0xffff0000, v68
    v_lshlrev_b32 v160, 16, v69
    v_and_b32 v168, 0xffff0000, v69
    v_lshlrev_b32 v145, 16, v70
    v_and_b32 v153, 0xffff0000, v70
    v_lshlrev_b32 v161, 16, v71
    v_and_b32 v169, 0xffff0000, v71
    v_lshlrev_b32 v146, 16, v72
    v_and_b32 v154, 0xffff0000, v72
    v_lshlrev_b32 v162, 16, v73
    v_and_b32 v170, 0xffff0000, v73
    v_lshlrev_b32 v147, 16, v74
    v_and_b32 v155, 0xffff0000, v74
    v_lshlrev_b32 v163, 16, v75
    v_and_b32 v171, 0xffff0000, v75
    v_lshlrev_b32 v148, 16, v76
    v_and_b32 v156, 0xffff0000, v76
    v_lshlrev_b32 v164, 16, v77
    v_and_b32 v172, 0xffff0000, v77
    v_lshlrev_b32 v149, 16, v78
    v_and_b32 v157, 0xffff0000, v78
    v_lshlrev_b32 v165, 16, v79
    v_and_b32 v173, 0xffff0000, v79
    v_lshlrev_b32 v150, 16, v80
    v_and_b32 v158, 0xffff0000, v80
    v_lshlrev_b32 v166, 16, v81
    v_and_b32 v174, 0xffff0000, v81
    v_lshlrev_b32 v151, 16, v82
    v_and_b32 v159, 0xffff0000, v82
    v_lshlrev_b32 v167, 16, v83
    v_and_b32 v175, 0xffff0000, v83
    v_lshlrev_b32 v192, 16, v52
    v_and_b32 v193, 0xffff0000, v52
    v_lshlrev_b32 v194, 16, v53
    v_and_b32 v195, 0xffff0000, v53
    v_lshlrev_b32 v196, 16, v54
    v_and_b32 v197, 0xffff0000, v54
    v_lshlrev_b32 v198, 16, v55
    v_and_b32 v199, 0xffff0000, v55
    v_lshlrev_b32 v200, 16, v56
    v_and_b32 v201, 0xffff0000, v56
    v_lshlrev_b32 v202, 16, v57
    v_and_b32 v203, 0xffff0000, v57
    v_lshlrev_b32 v204, 16, v58
    v_and_b32 v205, 0xffff0000, v58
    v_lshlrev_b32 v206, 16, v59
    v_and_b32 v207, 0xffff0000, v59
    v_pk_mul_f32 v[176:177], v[128:129], v[144:145]
    v_pk_mul_f32 v[178:179], v[130:131], v[146:147]
    v_pk_mul_f32 v[180:181], v[132:133], v[148:149]
    v_pk_mul_f32 v[182:183], v[134:135], v[150:151]
    v_pk_fma_f32 v[176:177], v[120:121], v[152:153], v[176:177]
    v_pk_fma_f32 v[178:179], v[122:123], v[154:155], v[178:179]
    v_pk_fma_f32 v[180:181], v[124:125], v[156:157], v[180:181]
    v_pk_fma_f32 v[182:183], v[126:127], v[158:159], v[182:183]
    v_pk_fma_f32 v[176:177], v[112:113], v[160:161], v[176:177]
    v_pk_fma_f32 v[178:179], v[114:115], v[162:163], v[178:179]
    v_pk_fma_f32 v[180:181], v[116:117], v[164:165], v[180:181]
    v_pk_fma_f32 v[182:183], v[118:119], v[166:167], v[182:183]
    v_pk_fma_f32 v[176:177], v[104:105], v[168:169], v[176:177]
    v_pk_fma_f32 v[178:179], v[106:107], v[170:171], v[178:179]
    v_pk_fma_f32 v[180:181], v[108:109], v[172:173], v[180:181]
    v_pk_fma_f32 v[182:183], v[110:111], v[174:175], v[182:183]
    v_pk_mul_f32 v[184:185], v[136:137], v[144:145]
    v_pk_mul_f32 v[186:187], v[138:139], v[146:147]
    v_pk_mul_f32 v[188:189], v[140:141], v[148:149]
    v_pk_mul_f32 v[190:191], v[142:143], v[150:151]
    v_pk_fma_f32 v[184:185], v[128:129], v[152:153], v[184:185]
    v_pk_fma_f32 v[186:187], v[130:131], v[154:155], v[186:187]
    v_pk_fma_f32 v[188:189], v[132:133], v[156:157], v[188:189]
    v_pk_fma_f32 v[190:191], v[134:135], v[158:159], v[190:191]
    v_pk_fma_f32 v[184:185], v[120:121], v[160:161], v[184:185]
    v_pk_fma_f32 v[186:187], v[122:123], v[162:163], v[186:187]
    v_pk_fma_f32 v[188:189], v[124:125], v[164:165], v[188:189]
    v_pk_fma_f32 v[190:191], v[126:127], v[166:167], v[190:191]
    v_pk_fma_f32 v[184:185], v[112:113], v[168:169], v[184:185]
    v_pk_fma_f32 v[186:187], v[114:115], v[170:171], v[186:187]
    v_pk_fma_f32 v[188:189], v[116:117], v[172:173], v[188:189]
    v_pk_fma_f32 v[190:191], v[118:119], v[174:175], v[190:191]
    v_pk_mul_f32 v[176:177], v[176:177], v[192:193]
    v_pk_mul_f32 v[178:179], v[178:179], v[194:195]
    v_pk_mul_f32 v[180:181], v[180:181], v[196:197]
    v_pk_mul_f32 v[182:183], v[182:183], v[198:199]
    v_pk_mul_f32 v[184:185], v[184:185], v[200:201]
    v_pk_mul_f32 v[186:187], v[186:187], v[202:203]
    v_pk_mul_f32 v[188:189], v[188:189], v[204:205]
    v_pk_mul_f32 v[190:191], v[190:191], v[206:207]
    v_cvt_pk_bf16_f32 v208, v184, v176
    v_cvt_pk_bf16_f32 v209, v185, v177
    v_cvt_pk_bf16_f32 v210, v186, v178
    v_cvt_pk_bf16_f32 v211, v187, v179
    v_cvt_pk_bf16_f32 v212, v188, v180
    v_cvt_pk_bf16_f32 v213, v189, v181
    v_cvt_pk_bf16_f32 v214, v190, v182
    v_cvt_pk_bf16_f32 v215, v191, v183
    v_lshlrev_b32 v226, 2, v92
    v_xor_b32 v225, v93, v226
    v_sub_u32 v224, 31, v93
    v_xor_b32 v224, v224, v226
    v_lshlrev_b32 v226, 10, v92
    v_lshl_add_u32 v224, v224, 2, v226
    v_lshl_add_u32 v225, v225, 2, v226
    ds_write_b32 v224, v208 offset:0
    ds_write_b32 v224, v209 offset:128
    ds_write_b32 v224, v210 offset:256
    ds_write_b32 v224, v211 offset:384
    ds_write_b32 v224, v212 offset:512
    ds_write_b32 v224, v213 offset:640
    ds_write_b32 v224, v214 offset:768
    ds_write_b32 v224, v215 offset:896
    s_waitcnt lgkmcnt(0)
    s_barrier
    v_lshrrev_b32 v232, 3, v0
    v_lshrrev_b32 v233, 3, v232
    v_and_b32 v234, 7, v0
    v_xor_b32 v235, v234, v233
    v_xor_b32 v236, 4, v235
    v_lshlrev_b32 v237, 7, v232
    v_lshl_add_u32 v235, v235, 4, v237
    v_lshl_add_u32 v236, v236, 4, v237
    ds_read_b128 v[128:131], v235 offset:0
    ds_read_b128 v[132:135], v236 offset:4096
    v_lshlrev_b32 v238, 12, v232
    v_lshl_add_u32 v238, v234, 4, v238
    v_add_u32 v239, 0x20000, v238
    s_lshl_b32 s50, s30, 18
    s_lshl_b32 s51, s31, 7
    s_sub_u32 s52, 3968, s51
    s_add_u32 s52, s52, s50
    s_add_u32 s52, s52, 0x0
    s_waitcnt lgkmcnt(1)
    buffer_store_dwordx4 v[128:131], v238, s[32:35], s52 offen offset:0 sc1
    s_waitcnt lgkmcnt(0)
    buffer_store_dwordx4 v[132:135], v239, s[32:35], s52 offen offset:0 sc1
    s_waitcnt lgkmcnt(0)
    s_lshl_b32 s50, s56, 16
    s_and_b32 s51, s56, 0xffff0000
    s_cmp_lt_u32 s3, 2
    s_cselect_b32 s56, s50, s51
    v_mov_b32 v31, 0
    global_load_dword v31, v31, s[26:27] sc1
    s_waitcnt vmcnt(8)
    s_mov_b32 s50, 0x05040100
    s_mov_b32 s51, 0x07060302
    v_perm_b32 v216, v64, v60, s50
    v_perm_b32 v217, v64, v60, s51
    v_perm_b32 v218, v65, v61, s50
    v_perm_b32 v219, v65, v61, s51
    v_perm_b32 v220, v66, v62, s50
    v_perm_b32 v221, v66, v62, s51
    v_perm_b32 v222, v67, v63, s50
    v_perm_b32 v223, v67, v63, s51
    v_lshlrev_b32 v226, 2, v92
    v_xor_b32 v225, v93, v226
    v_lshlrev_b32 v226, 10, v92
    v_lshl_add_u32 v225, v225, 2, v226
    v_add_u32 v225, 0x24800, v225
    ds_write_b32 v225, v216 offset:0
    ds_write_b32 v225, v217 offset:128
    ds_write_b32 v225, v218 offset:256
    ds_write_b32 v225, v219 offset:384
    ds_write_b32 v225, v220 offset:512
    ds_write_b32 v225, v221 offset:640
    ds_write_b32 v225, v222 offset:768
    ds_write_b32 v225, v223 offset:896
    s_waitcnt vmcnt(6)
    v_lshlrev_b32 v104, 16, v84
    v_and_b32 v105, 0xffff0000, v84
    v_lshlrev_b32 v106, 16, v85
    v_and_b32 v107, 0xffff0000, v85
    v_lshlrev_b32 v108, 16, v86
    v_and_b32 v109, 0xffff0000, v86
    v_lshlrev_b32 v110, 16, v87
    v_and_b32 v111, 0xffff0000, v87
    v_lshlrev_b32 v112, 16, v88
    v_and_b32 v113, 0xffff0000, v88
    v_lshlrev_b32 v114, 16, v89
    v_and_b32 v115, 0xffff0000, v89
    v_lshlrev_b32 v116, 16, v90
    v_and_b32 v117, 0xffff0000, v90
    v_lshlrev_b32 v118, 16, v91
    v_and_b32 v119, 0xffff0000, v91
    v_pk_add_f32 v[120:121], v[104:105], v[106:107]
    v_pk_add_f32 v[122:123], v[108:109], v[110:111]
    v_pk_add_f32 v[124:125], v[112:113], v[114:115]
    v_pk_add_f32 v[126:127], v[116:117], v[118:119]
    v_pk_add_f32 v[120:121], v[120:121], v[122:123]
    v_pk_add_f32 v[124:125], v[124:125], v[126:127]
    v_add_f32 v120, v120, v121
    v_add_f32 v124, v124, v125
    s_nop 0
    v_add_f32_dpp v120, v120, v120 row_shr:1 row_mask:0xf bank_mask:0xf bound_ctrl:0
    v_add_f32_dpp v124, v124, v124 row_shr:1 row_mask:0xf bank_mask:0xf bound_ctrl:0
    s_nop 0
    v_add_f32_dpp v120, v120, v120 row_shr:2 row_mask:0xf bank_mask:0xf bound_ctrl:0
    v_add_f32_dpp v124, v124, v124 row_shr:2 row_mask:0xf bank_mask:0xf bound_ctrl:0
    s_nop 0
    v_add_f32_dpp v120, v120, v120 row_shr:4 row_mask:0xf bank_mask:0xf bound_ctrl:0
    v_add_f32_dpp v124, v124, v124 row_shr:4 row_mask:0xf bank_mask:0xf bound_ctrl:0
    s_nop 0
    v_add_f32_dpp v120, v120, v120 row_shr:8 row_mask:0xf bank_mask:0xf bound_ctrl:0
    v_add_f32_dpp v124, v124, v124 row_shr:8 row_mask:0xf bank_mask:0xf bound_ctrl:0
    s_nop 0
    v_add_f32_dpp v120, v120, v120 row_bcast:15 row_mask:0xa bank_mask:0xf
    v_add_f32_dpp v124, v124, v124 row_bcast:15 row_mask:0xa bank_mask:0xf
    s_nop 0
    v_add_f32_dpp v120, v120, v120 row_bcast:31 row_mask:0xc bank_mask:0xf
    v_add_f32_dpp v124, v124, v124 row_bcast:31 row_mask:0xc bank_mask:0xf
    s_nop 0
    v_readlane_b32 s54, v120, 63
    v_readlane_b32 s55, v124, 63
    s_nop 1
    v_mov_b32 v128, 0x3b000000
    v_mul_f32 v129, s54, v128
    v_mul_f32 v130, s55, v128
    v_sub_f32 v104, v104, v129
    v_sub_f32 v105, v105, v129
    v_sub_f32 v106, v106, v129
    v_sub_f32 v107, v107, v129
    v_sub_f32 v108, v108, v129
    v_sub_f32 v109, v109, v129
    v_sub_f32 v110, v110, v129
    v_sub_f32 v111, v111, v129
    v_sub_f32 v112, v112, v130
    v_sub_f32 v113, v113, v130
    v_sub_f32 v114, v114, v130
    v_sub_f32 v115, v115, v130
    v_sub_f32 v116, v116, v130
    v_sub_f32 v117, v117, v130
    v_sub_f32 v118, v118, v130
    v_sub_f32 v119, v119, v130
    v_pk_mul_f32 v[120:121], v[104:105], v[104:105]
    v_pk_fma_f32 v[120:121], v[106:107], v[106:107], v[120:121]
    v_pk_fma_f32 v[120:121], v[108:109], v[108:109], v[120:121]
    v_pk_fma_f32 v[120:121], v[110:111], v[110:111], v[120:121]
    v_pk_mul_f32 v[124:125], v[112:113], v[112:113]
    v_pk_fma_f32 v[124:125], v[114:115], v[114:115], v[124:125]
    v_pk_fma_f32 v[124:125], v[116:117], v[116:117], v[124:125]
    v_pk_fma_f32 v[124:125], v[118:119], v[118:119], v[124:125]
    v_add_f32 v120, v120, v121
    v_add_f32 v124, v124, v125
    s_nop 0
    v_add_f32_dpp v120, v120, v120 row_shr:1 row_mask:0xf bank_mask:0xf bound_ctrl:0
    v_add_f32_dpp v124, v124, v124 row_shr:1 row_mask:0xf bank_mask:0xf bound_ctrl:0
    s_nop 0
    v_add_f32_dpp v120, v120, v120 row_shr:2 row_mask:0xf bank_mask:0xf bound_ctrl:0
    v_add_f32_dpp v124, v124, v124 row_shr:2 row_mask:0xf bank_mask:0xf bound_ctrl:0
    s_nop 0
    v_add_f32_dpp v120, v120, v120 row_shr:4 row_mask:0xf bank_mask:0xf bound_ctrl:0
    v_add_f32_dpp v124, v124, v124 row_shr:4 row_mask:0xf bank_mask:0xf bound_ctrl:0
    s_nop 0
    v_add_f32_dpp v120, v120, v120 row_shr:8 row_mask:0xf bank_mask:0xf bound_ctrl:0
    v_add_f32_dpp v124, v124, v124 row_shr:8 row_mask:0xf bank_mask:0xf bound_ctrl:0
    s_nop 0
    v_add_f32_dpp v120, v120, v120 row_bcast:15 row_mask:0xa bank_mask:0xf
    v_add_f32_dpp v124, v124, v124 row_bcast:15 row_mask:0xa bank_mask:0xf
    s_nop 0
    v_add_f32_dpp v120, v120, v120 row_bcast:31 row_mask:0xc bank_mask:0xf
    v_add_f32_dpp v124, v124, v124 row_bcast:31 row_mask:0xc bank_mask:0xf
    s_nop 0
    v_readlane_b32 s54, v120, 63
    v_readlane_b32 s55, v124, 63
    s_nop 1
    v_mov_b32 v131, 0x3727c5ac
    v_fma_f32 v120, s54, v128, v131
    v_fma_f32 v122, s55, v128, v131
    v_rsq_f32 v120, v120
    v_rsq_f32 v122, v122
    s_nop 0
    v_mul_f32 v121, v129, v120
    v_mul_f32 v123, v130, v122
    v_sub_f32 v121, 0, v121
    v_sub_f32 v123, 0, v123
    s_lshl_b32 s50, s3, 4
    s_add_u32 s50, s50, 0x26800
    v_mov_b32 v132, s50
    s_mov_b64 s[52:53], exec
    s_mov_b64 exec, 1
    ds_write_b128 v132, v[120:123]
    s_mov_b64 exec, s[52:53]
    s_waitcnt vmcnt(3)
    s_waitcnt lgkmcnt(0)
    s_barrier
    s_sub_u32 s50, s3, 1
    s_lshl_b32 s50, s50, 6
    s_cmp_eq_u32 s3, 0
    s_cselect_b32 s50, 0x1000, s50
    s_lshl_b32 s51, s30, 18
    s_lshl_b32 s52, s31, 7
    s_add_u32 s53, s51, s52
    s_add_u32 s53, s53, 0x200000
    v_add_u32 v232, s50, v1
    v_lshrrev_b32 v233, 3, v232
    v_and_b32 v233, 63, v233
    v_and_b32 v234, 7, v232
    v_lshrrev_b32 v235, 3, v233
    v_xor_b32 v235, v235, v234
    v_lshlrev_b32 v235, 4, v235
    v_lshl_add_u32 v235, v233, 7, v235
    v_add_u32 v235, 0x24800, v235
    ds_read_b128 v[128:131], v235
    v_lshlrev_b32 v236, 12, v233
    v_lshl_add_u32 v236, v234, 4, v236
    v_cmp_gt_u32 vcc, 512, v232
    v_mov_b32 v234, 0x40000000
    s_nop 0
    v_cndmask_b32 v236, v234, v236, vcc
    v_add_u32 v232, s50, v1
    v_add_u32 v232, 192, v232
    v_lshrrev_b32 v233, 3, v232
    v_and_b32 v233, 63, v233
    v_and_b32 v234, 7, v232
    v_lshrrev_b32 v235, 3, v233
    v_xor_b32 v235, v235, v234
    v_lshlrev_b32 v235, 4, v235
    v_lshl_add_u32 v235, v233, 7, v235
    v_add_u32 v235, 0x24800, v235
    ds_read_b128 v[132:135], v235
    v_lshlrev_b32 v237, 12, v233
    v_lshl_add_u32 v237, v234, 4, v237
    v_cmp_gt_u32 vcc, 512, v232
    v_mov_b32 v234, 0x40000000
    s_nop 0
    v_cndmask_b32 v237, v234, v237, vcc
    v_add_u32 v232, s50, v1
    v_add_u32 v232, 384, v232
    v_lshrrev_b32 v233, 3, v232
    v_and_b32 v233, 63, v233
    v_and_b32 v234, 7, v232
    v_lshrrev_b32 v235, 3, v233
    v_xor_b32 v235, v235, v234
    v_lshlrev_b32 v235, 4, v235
    v_lshl_add_u32 v235, v233, 7, v235
    v_add_u32 v235, 0x24800, v235
    ds_read_b128 v[136:139], v235
    v_lshlrev_b32 v238, 12, v233
    v_lshl_add_u32 v238, v234, 4, v238
    v_cmp_gt_u32 vcc, 512, v232
    v_mov_b32 v234, 0x40000000
    s_nop 0
    v_cndmask_b32 v238, v234, v238, vcc
    v_lshlrev_b32 v232, 4, v1
    v_and_b32 v233, 0x70, v232
    v_add_u32 v233, 0x26800, v233
    ds_read_b128 v[140:143], v233
    s_waitcnt lgkmcnt(3)
    buffer_store_dwordx4 v[128:131], v236, s[32:35], s53 offen offset:0 sc1
    s_waitcnt lgkmcnt(2)
    buffer_store_dwordx4 v[132:135], v237, s[32:35], s53 offen offset:0 sc1
    s_waitcnt lgkmcnt(1)
    buffer_store_dwordx4 v[136:139], v238, s[32:35], s53 offen offset:0 sc1
    s_waitcnt lgkmcnt(0)
    v_cmp_gt_u32 vcc, 4, v1
    s_cmp_eq_u32 s3, 2
    s_cselect_b32 s51, 8, 0
    v_cndmask_b32 v140, 0, v140, vcc
    v_cndmask_b32 v141, 0, v141, vcc
    v_cndmask_b32 v142, 0, v142, vcc
    v_cndmask_b32 v143, 0, v143, vcc
    v_cmp_gt_u32 vcc, s51, v1
    v_mov_b32 v233, 0x40000000
    s_lshl_b32 s50, s2, 7
    v_cndmask_b32 v232, v233, v232, vcc
    s_add_u32 s50, s50, 0x1500000
    buffer_store_dwordx4 v[140:143], v232, s[32:35], s50 offen offset:0 sc1
    s_lshl_b32 s50, s48, 3
    s_add_u32 s50, s50, s49
    s_lshl_b32 s50, s50, 9
    s_add_u32 s50, s50, 0x1520000
    s_cmp_eq_u32 s3, 1
    s_cselect_b32 s50, s50, 0x40000000
    v_lshlrev_b32 v234, 3, v1
    v_mov_b32 v128, 0
    v_mov_b32 v129, -1.0
    buffer_store_dwordx2 v[128:129], v234, s[32:35], s50 offen offset:0 sc1
    v_lshrrev_b32 v240, 2, v27
    v_lshl_add_u32 v240, v28, 2, v240
    v_mul_u32_u24 v241, 224, v240
    v_and_b32 v242, 3, v1
    v_lshl_add_u32 v241, v242, 3, v241
    v_add_u32 v241, 0x14800, v241
    v_lshlrev_b32 v242, 7, v240
    v_and_b32 v243, 1, v1
    v_lshl_add_u32 v242, v243, 3, v242
    v_bfe_u32 v243, v1, 1, 1
    v_lshl_add_u32 v242, v243, 4, v242
    v_add_u32 v242, 0x16400, v242
    v_and_b32 v243, 1, v28
    v_lshlrev_b32 v243, 2, v243
    v_bfe_u32 v240, v1, 3, 1
    v_lshl_add_u32 v243, v240, 1, v243
    v_lshlrev_b32 v240, 4, v1
    s_lshr_b32 s52, s2, 4
    s_mul_i32 s52, s52, 112
    s_and_b32 s50, s2, 15
    s_add_u32 s52, s52, s50
    s_lshl_b32 s52, s52, 10
    s_add_u32 s52, s52, 0x1200000
    s_mul_i32 s50, s2, 2341
    s_lshr_b32 s50, s50, 16
    s_mul_i32 s51, s50, 28
    s_sub_u32 s51, s2, s51
    s_mul_i32 s53, s50, 112
    s_add_u32 s53, s53, s51
    s_lshl_b32 s53, s53, 10
    s_add_u32 s53, s53, 0x1400000
    s_cmp_ge_u32 s2, 224
    s_cselect_b32 s53, 0x40000000, s53
    s_sub_u32 s54, s3, 1
    s_lshl_b32 s54, s54, 2
    s_cmp_eq_u32 s3, 0
    s_cselect_b32 s54, 11, s54
    s_add_u32 s55, s54, 0
    s_cmp_lt_u32 s55, 7
    s_cbranch_scc1 wq_3
    s_sub_u32 s55, s55, 7
    s_lshl_b32 s50, s55, 1
    s_and_b32 s50, s50, 7
    v_xor_b32 v244, s50, v243
    v_lshl_add_u32 v244, v244, 4, v242
    ds_read_b64_tr_b16 v[176:177], v244
    ds_read_b64_tr_b16 v[178:179], v244 offset:2048
    s_mul_i32 s60, s55, 28672
    s_add_u32 s60, s60, s53
    s_cmp_ge_u32 s55, 4
    s_cselect_b32 s60, 0x40000000, s60
    s_branch wqd_4
wq_3:
    s_lshl_b32 s50, s55, 5
    v_add_u32 v244, s50, v241
    ds_read_b64_tr_b16 v[176:177], v244
    ds_read_b64_tr_b16 v[178:179], v244 offset:3584
    s_lshl_b32 s60, s55, 14
    s_add_u32 s60, s60, s52
wqd_4:
    s_add_u32 s55, s54, 1
    s_cmp_lt_u32 s55, 7
    s_cbranch_scc1 wq_5
    s_sub_u32 s55, s55, 7
    s_lshl_b32 s50, s55, 1
    s_and_b32 s50, s50, 7
    v_xor_b32 v244, s50, v243
    v_lshl_add_u32 v244, v244, 4, v242
    ds_read_b64_tr_b16 v[180:181], v244
    ds_read_b64_tr_b16 v[182:183], v244 offset:2048
    s_mul_i32 s61, s55, 28672
    s_add_u32 s61, s61, s53
    s_cmp_ge_u32 s55, 4
    s_cselect_b32 s61, 0x40000000, s61
    s_branch wqd_6
wq_5:
    s_lshl_b32 s50, s55, 5
    v_add_u32 v244, s50, v241
    ds_read_b64_tr_b16 v[180:181], v244
    ds_read_b64_tr_b16 v[182:183], v244 offset:3584
    s_lshl_b32 s61, s55, 14
    s_add_u32 s61, s61, s52
wqd_6:
    s_add_u32 s55, s54, 2
    s_cmp_lt_u32 s55, 7
    s_cbranch_scc1 wq_7
    s_sub_u32 s55, s55, 7
    s_lshl_b32 s50, s55, 1
    s_and_b32 s50, s50, 7
    v_xor_b32 v244, s50, v243
    v_lshl_add_u32 v244, v244, 4, v242
    ds_read_b64_tr_b16 v[184:185], v244
    ds_read_b64_tr_b16 v[186:187], v244 offset:2048
    s_mul_i32 s62, s55, 28672
    s_add_u32 s62, s62, s53
    s_cmp_ge_u32 s55, 4
    s_cselect_b32 s62, 0x40000000, s62
    s_branch wqd_8
wq_7:
    s_lshl_b32 s50, s55, 5
    v_add_u32 v244, s50, v241
    ds_read_b64_tr_b16 v[184:185], v244
    ds_read_b64_tr_b16 v[186:187], v244 offset:3584
    s_lshl_b32 s62, s55, 14
    s_add_u32 s62, s62, s52
wqd_8:
    s_add_u32 s55, s54, 3
    s_cmp_lt_u32 s55, 7
    s_cbranch_scc1 wq_9
    s_sub_u32 s55, s55, 7
    s_lshl_b32 s50, s55, 1
    s_and_b32 s50, s50, 7
    v_xor_b32 v244, s50, v243
    v_lshl_add_u32 v244, v244, 4, v242
    ds_read_b64_tr_b16 v[188:189], v244
    ds_read_b64_tr_b16 v[190:191], v244 offset:2048
    s_mul_i32 s63, s55, 28672
    s_add_u32 s63, s63, s53
    s_cmp_ge_u32 s55, 4
    s_cselect_b32 s63, 0x40000000, s63
    s_branch wqd_10
wq_9:
    s_lshl_b32 s50, s55, 5
    v_add_u32 v244, s50, v241
    ds_read_b64_tr_b16 v[188:189], v244
    ds_read_b64_tr_b16 v[190:191], v244 offset:3584
    s_lshl_b32 s63, s55, 14
    s_add_u32 s63, s63, s52
wqd_10:
    s_waitcnt lgkmcnt(0)
    buffer_store_dwordx4 v[176:179], v240, s[32:35], s60 offen offset:0 sc1
    buffer_store_dwordx4 v[180:183], v240, s[32:35], s61 offen offset:0 sc1
    buffer_store_dwordx4 v[184:187], v240, s[32:35], s62 offen offset:0 sc1
    buffer_store_dwordx4 v[188:191], v240, s[32:35], s63 offen offset:0 sc1
    v_lshlrev_b32 v99, 4, v1
    s_mov_b32 s40, s12
    s_mov_b32 s41, s13
    s_mov_b32 s42, 0x200000
    s_mov_b32 s43, 0x20000
    s_lshl_b32 s50, s30, 6
    s_lshl_b32 s51, s31, 1
    s_add_u32 s50, s50, s51
    s_lshr_b32 s51, s3, 1
    s_add_u32 s50, s50, s51
    s_lshl_b32 s50, s50, 12
    s_and_b32 s52, s3, 1
    s_lshl_b32 s52, s52, 11
    s_add_u32 s50, s50, s52
    s_mul_i32 s51, s51, 4128
    s_add_u32 s51, s51, s52
    s_add_u32 m0, s51, 0x127e0
    s_nop 0
    buffer_load_dwordx4 v99, s[40:43], s50 offen lds
    s_add_u32 s50, s50, 1024
    s_add_u32 m0, s51, 0x12be0
    s_nop 0
    buffer_load_dwordx4 v99, s[40:43], s50 offen lds
    v_mov_b32 v100, 0
    v_mov_b32 v101, 0
    v_lshrrev_b32 v102, 2, v0
    v_mul_u32_u24 v102, 4128, v102
    v_and_b32 v103, 3, v0
    v_lshl_add_u32 v102, v103, 3, v102
    v_add_u32 v102, 0x127c0, v102
    v_cmp_gt_u32 vcc, 8, v0
    s_and_saveexec_b64 s[52:53], vcc
    ds_write_b64 v102, v[100:101]
    s_mov_b64 exec, s[52:53]
    s_cmp_lt_u32 s3, 2
    s_cbranch_scc0 ubz_11
    s_mul_i32 s50, s3, 4576
    s_add_u32 s50, s50, 0x11400
    v_lshlrev_b32 v102, 3, v1
    v_add_u32 v102, s50, v102
    v_cmp_gt_u32 vcc, 60, v1
    s_and_saveexec_b64 s[52:53], vcc
    ds_write_b64 v102, v[100:101]
    s_mov_b64 exec, s[52:53]
ubz_11:
    s_waitcnt vmcnt(2)
    s_cmp_eq_u32 s3, 0
    s_cbranch_scc0 wb_12
    v_readfirstlane_b32 s50, v31
    s_mov_b32 s51, 0
    s_nop 3
    s_cmp_lg_u32 s50, 0
    s_cbranch_scc1 wbd_14
    v_mov_b32 v29, 0
wbl_13:
    global_load_dword v30, v29, s[26:27] sc1
    s_waitcnt vmcnt(0)
    v_readfirstlane_b32 s50, v30
    s_nop 3
    s_cmp_lg_u32 s50, 0
    s_cbranch_scc1 wbd_14
    s_add_u32 s51, s51, 1
    s_cmp_lt_u32 s51, 0x200000
    s_cbranch_scc1 wbl_13
wbd_14:
wb_12:
    s_waitcnt lgkmcnt(0)
    s_barrier
    s_cmp_eq_u32 s3, 0
    s_cbranch_scc0 ga_15
    s_and_b32 s50, s2, 15
    v_lshlrev_b32 v29, 4, v1
    v_add_u32 v29, s50, v29
    v_lshlrev_b32 v29, 8, v29
    v_add_u32 v29, 0x1550000, v29
    v_mov_b32 v30, 1
    s_mov_b64 s[52:53], exec
    s_mov_b64 exec, 15
    global_atomic_add v29, v30, s[28:29] sc1
    s_mov_b64 exec, s[52:53]
ga_15:
    s_waitcnt vmcnt(0)
    s_waitcnt lgkmcnt(0)
    s_barrier
    v_lshrrev_b32 v104, 7, v0
    v_and_b32 v105, 127, v0
    v_mul_u32_u24 v106, 4128, v104
    v_lshl_add_u32 v106, v105, 4, v106
    v_add_u32 v106, 0x127c0, v106
    v_mul_u32_u24 v107, 33280, v104
    v_lshl_add_u32 v107, v105, 4, v107
    ds_read_b128 v[112:115], v106 offset:0
    ds_read_b128 v[116:119], v106 offset:16
    ds_read_b128 v[144:147], v106 offset:2048
    ds_read_b128 v[148:151], v106 offset:2064
    ds_read_b128 v[176:179], v106 offset:4096
    ds_read_b128 v[180:183], v106 offset:4112
    s_waitcnt lgkmcnt(4)
    v_alignbit_b32 v128, v113, v112, 16
    v_alignbit_b32 v129, v114, v113, 16
    v_alignbit_b32 v130, v115, v114, 16
    v_alignbit_b32 v131, v116, v115, 16
    v_alignbit_b32 v132, v117, v116, 16
    v_alignbit_b32 v133, v118, v117, 16
    v_alignbit_b32 v134, v119, v118, 16
    v_alignbit_b32 v136, v114, v113, 16
    v_alignbit_b32 v137, v115, v114, 16
    v_alignbit_b32 v138, v116, v115, 16
    v_alignbit_b32 v139, v117, v116, 16
    v_alignbit_b32 v140, v118, v117, 16
    v_alignbit_b32 v141, v119, v118, 16
    v_mov_b32 v120, v113
    v_mov_b32 v121, v114
    v_mov_b32 v122, v115
    v_mov_b32 v123, v116
    v_mov_b32 v124, v117
    v_mov_b32 v125, v118
    ds_write_b128 v107, v[114:117] offset:12480
    ds_write_b128 v107, v[116:119] offset:29120
    ds_write_b128 v107, v[128:131] offset:0
    ds_write_b128 v107, v[130:133] offset:16640
    ds_write_b128 v107, v[120:123] offset:4160
    ds_write_b128 v107, v[122:125] offset:20800
    ds_write_b128 v107, v[136:139] offset:8320
    ds_write_b128 v107, v[138:141] offset:24960
    s_waitcnt lgkmcnt(10)
    v_alignbit_b32 v160, v145, v144, 16
    v_alignbit_b32 v161, v146, v145, 16
    v_alignbit_b32 v162, v147, v146, 16
    v_alignbit_b32 v163, v148, v147, 16
    v_alignbit_b32 v164, v149, v148, 16
    v_alignbit_b32 v165, v150, v149, 16
    v_alignbit_b32 v166, v151, v150, 16
    v_alignbit_b32 v168, v146, v145, 16
    v_alignbit_b32 v169, v147, v146, 16
    v_alignbit_b32 v170, v148, v147, 16
    v_alignbit_b32 v171, v149, v148, 16
    v_alignbit_b32 v172, v150, v149, 16
    v_alignbit_b32 v173, v151, v150, 16
    v_mov_b32 v152, v145
    v_mov_b32 v153, v146
    v_mov_b32 v154, v147
    v_mov_b32 v155, v148
    v_mov_b32 v156, v149
    v_mov_b32 v157, v150
    ds_write_b128 v107, v[146:149] offset:14528
    ds_write_b128 v107, v[148:151] offset:31168
    ds_write_b128 v107, v[160:163] offset:2048
    ds_write_b128 v107, v[162:165] offset:18688
    ds_write_b128 v107, v[152:155] offset:6208
    s_waitcnt lgkmcnt(14)
    ds_write_b128 v107, v[154:157] offset:22848
    s_waitcnt lgkmcnt(14)
    ds_write_b128 v107, v[168:171] offset:10368
    s_waitcnt lgkmcnt(14)
    ds_write_b128 v107, v[170:173] offset:27008
    v_cmp_eq_u32 vcc, 0, v105
    s_and_saveexec_b64 s[52:53], vcc
    v_alignbit_b32 v192, v177, v176, 16
    v_alignbit_b32 v193, v178, v177, 16
    v_alignbit_b32 v194, v179, v178, 16
    v_alignbit_b32 v195, v180, v179, 16
    v_alignbit_b32 v196, v181, v180, 16
    v_alignbit_b32 v197, v182, v181, 16
    v_alignbit_b32 v198, v183, v182, 16
    v_alignbit_b32 v200, v178, v177, 16
    v_alignbit_b32 v201, v179, v178, 16
    v_alignbit_b32 v202, v180, v179, 16
    v_alignbit_b32 v203, v181, v180, 16
    v_alignbit_b32 v204, v182, v181, 16
    v_alignbit_b32 v205, v183, v182, 16
    v_mov_b32 v184, v177
    v_mov_b32 v185, v178
    v_mov_b32 v186, v179
    v_mov_b32 v187, v180
    v_mov_b32 v188, v181
    v_mov_b32 v189, v182
    s_waitcnt lgkmcnt(14)
    ds_write_b128 v107, v[178:181] offset:16576
    s_waitcnt lgkmcnt(14)
    ds_write_b128 v107, v[180:183] offset:33216
    s_waitcnt lgkmcnt(14)
    ds_write_b128 v107, v[192:195] offset:4096
    s_waitcnt lgkmcnt(14)
    ds_write_b128 v107, v[194:197] offset:20736
    s_waitcnt lgkmcnt(14)
    ds_write_b128 v107, v[184:187] offset:8256
    s_waitcnt lgkmcnt(14)
    ds_write_b128 v107, v[186:189] offset:24896
    s_waitcnt lgkmcnt(14)
    ds_write_b128 v107, v[200:203] offset:12416
    s_waitcnt lgkmcnt(14)
    ds_write_b128 v107, v[202:205] offset:29056
    s_mov_b64 exec, s[52:53]
    v_lshlrev_b32 v240, 4, v1
    v_add_u32 v241, 0x40000000, v240
    s_cmp_eq_u32 s3, 3
    s_cselect_b64 vcc, -1, 0
    v_cndmask_b32 v241, v240, v241, vcc
    s_mul_i32 s59, s49, 7
    s_lshl_b32 s50, s3, 1
    s_add_u32 s59, s59, s50
    s_lshl_b32 s59, s59, 14
    s_add_u32 s59, s59, 0x1200000
    s_add_u32 s58, s59, 917504
    s_waitcnt lgkmcnt(0)
    s_cmp_eq_u32 s3, 0
    s_cbranch_scc0 gp_16
    s_lshr_b32 s50, s2, 4
    s_and_b32 s50, s50, 3
    s_lshl_b32 s50, s50, 4
    v_add_u32 v29, s50, v1
    v_lshlrev_b32 v29, 8, v29
    v_add_u32 v29, 0x1550000, v29
    s_mov_b64 s[52:53], exec
    s_mov_b64 exec, 0xffff
    global_load_dword v30, v29, s[28:29] sc1
    s_mov_b32 s51, 0
gl_17:
    s_waitcnt vmcnt(0)
    v_cmp_gt_u32 vcc, 16, v30
    s_nop 1
    s_cmp_eq_u64 vcc, 0
    s_cbranch_scc1 gd_18
    global_load_dword v30, v29, s[28:29] sc1
    s_add_u32 s51, s51, 1
    s_cmp_lt_u32 s51, 0x200000
    s_cbranch_scc1 gl_17
    s_waitcnt vmcnt(0)
gd_18:
    s_mov_b64 exec, s[52:53]
gp_16:
    s_barrier
    s_lshl_b32 s50, s30, 6
    s_lshl_b32 s51, s31, 1
    s_add_u32 s50, s50, s51
    s_lshr_b32 s51, s3, 1
    s_add_u32 s50, s50, s51
    s_lshl_b32 s57, s50, 12
    s_and_b32 s52, s3, 1
    s_lshl_b32 s52, s52, 11
    s_add_u32 s53, s57, s52
    s_add_u32 s53, s53, 0x0
    s_mul_i32 s51, s51, 4576
    s_add_u32 s51, s51, s52
    v_lshlrev_b32 v32, 4, v1
    s_add_u32 m0, s51, 0x10400
    s_nop 0
    buffer_load_dwordx4 v32, s[32:35], s53 offen sc1 lds
    s_add_u32 s53, s53, 1024
    s_add_u32 m0, s51, 0x10800
    s_nop 0
    buffer_load_dwordx4 v32, s[32:35], s53 offen sc1 lds
    v_lshlrev_b32 v33, 5, v27
    v_lshl_add_u32 v33, v28, 3, v33
    s_and_b32 s50, s3, 1
    s_lshl_b32 s60, s50, 11
    s_add_u32 s60, s60, s57
    s_add_u32 s60, s60, 0x200000
    v_and_b32 v39, 7, v1
    v_lshlrev_b32 v39, 8, v39
    v_bfe_u32 v38, v1, 4, 1
    v_lshl_add_u32 v39, v38, 7, v39
    v_bfe_u32 v38, v1, 3, 1
    v_lshl_add_u32 v39, v38, 5, v39
    v_lshrrev_b32 v38, 5, v1
    v_lshl_add_u32 v39, v38, 4, v39
    s_lshl_b32 s61, s3, 12
    s_lshl_b32 s62, s3, 13
    s_add_u32 s62, s62, 0x1500000
    s_waitcnt vmcnt(0)
    s_barrier
    v_and_b32 v34, 7, v1
    v_mul_u32_u24 v34, 4160, v34
    v_bfe_u32 v35, v1, 3, 1
    v_add_u32 v35, v35, v28
    v_lshl_add_u32 v34, v35, 4, v34
    s_lshr_b32 s50, s3, 1
    s_and_b32 s51, s3, 1
    s_mul_i32 s52, s50, 33280
    s_lshl_b32 s53, s51, 8
    s_add_u32 s52, s52, s53
    v_add_u32 v34, s52, v34
    s_mul_i32 s52, s50, 4576
    s_add_u32 s52, s52, s53
    s_add_u32 s52, s52, 67040
    v_lshlrev_b32 v35, 4, v28
    v_lshlrev_b32 v36, 5, v27
    v_sub_u32 v35, v35, v36
    v_add_u32 v35, s52, v35
    ds_read_b128 v[40:43], v34 offset:0
    ds_read_b128 v[72:75], v35 offset:3584
    ds_read_b128 v[44:47], v34 offset:512
    ds_read_b128 v[76:79], v35 offset:3072
    ds_read_b128 v[48:51], v34 offset:1024
    ds_read_b128 v[80:83], v35 offset:2560
    ds_read_b128 v[52:55], v34 offset:1536
    ds_read_b128 v[84:87], v35 offset:2048
    ds_read_b128 v[56:59], v34 offset:2048
    ds_read_b128 v[88:91], v35 offset:1536
    ds_read_b128 v[60:63], v34 offset:2560
    ds_read_b128 v[92:95], v35 offset:1024
    ds_read_b128 v[64:67], v34 offset:3072
    ds_read_b128 v[96:99], v35 offset:512
    ds_read_b128 v[68:71], v34 offset:3584
    s_waitcnt lgkmcnt(14)
    ds_read_b128 v[100:103], v35 offset:0
    s_waitcnt lgkmcnt(0)
    v_mfma_f32_16x16x32_bf16 v[168:171], v[40:43], v[72:75], 0
    s_add_u32 s50, s62, 0
    s_add_u32 m0, s61, 0x18000
    s_nop 0
    buffer_load_dwordx4 v39, s[32:35], s50 offen sc1 lds
    v_mfma_f32_16x16x32_bf16 v[172:175], v[40:43], v[76:79], 0
    ds_read_b128 v[104:107], v34 offset:64
    v_mfma_f32_16x16x32_bf16 v[176:179], v[40:43], v[80:83], 0
    v_mfma_f32_16x16x32_bf16 v[180:183], v[40:43], v[84:87], 0
    ds_read_b128 v[136:139], v35 offset:3648
    s_add_u32 s50, s62, 2048
    s_add_u32 m0, s61, 0x18400
    s_nop 0
    buffer_load_dwordx4 v39, s[32:35], s50 offen sc1 lds
    v_mfma_f32_16x16x32_bf16 v[184:187], v[40:43], v[88:91], 0
    v_mfma_f32_16x16x32_bf16 v[188:191], v[40:43], v[92:95], 0
    ds_read_b128 v[108:111], v34 offset:576
    v_mfma_f32_16x16x32_bf16 v[192:195], v[40:43], v[96:99], 0
    s_add_u32 s50, s62, 4096
    s_add_u32 m0, s61, 0x18800
    s_nop 0
    buffer_load_dwordx4 v39, s[32:35], s50 offen sc1 lds
    v_mfma_f32_16x16x32_bf16 v[196:199], v[40:43], v[100:103], 0
    ds_read_b128 v[140:143], v35 offset:3136
    v_mfma_f32_16x16x32_bf16 v[172:175], v[44:47], v[72:75], v[172:175]
    v_mfma_f32_16x16x32_bf16 v[176:179], v[44:47], v[76:79], v[176:179]
    ds_read_b128 v[112:115], v34 offset:1088
    s_add_u32 s50, s62, 6144
    s_add_u32 m0, s61, 0x18c00
    s_nop 0
    buffer_load_dwordx4 v39, s[32:35], s50 offen sc1 lds
    v_mfma_f32_16x16x32_bf16 v[180:183], v[44:47], v[80:83], v[180:183]
    v_mfma_f32_16x16x32_bf16 v[184:187], v[44:47], v[84:87], v[184:187]
    ds_read_b128 v[144:147], v35 offset:2624
    v_mfma_f32_16x16x32_bf16 v[188:191], v[44:47], v[88:91], v[188:191]
    buffer_load_dwordx2 v[200:201], v33, s[32:35], s60 offen offset:0 sc1
    v_mfma_f32_16x16x32_bf16 v[192:195], v[44:47], v[92:95], v[192:195]
    ds_read_b128 v[116:119], v34 offset:1600
    v_mfma_f32_16x16x32_bf16 v[196:199], v[44:47], v[96:99], v[196:199]
    v_mfma_f32_16x16x32_bf16 v[176:179], v[48:51], v[72:75], v[176:179]
    ds_read_b128 v[148:151], v35 offset:2112
    buffer_load_dwordx2 v[202:203], v33, s[32:35], s60 offen offset:512 sc1
    v_mfma_f32_16x16x32_bf16 v[180:183], v[48:51], v[76:79], v[180:183]
    v_mfma_f32_16x16x32_bf16 v[184:187], v[48:51], v[80:83], v[184:187]
    ds_read_b128 v[120:123], v34 offset:2112
    v_mfma_f32_16x16x32_bf16 v[188:191], v[48:51], v[84:87], v[188:191]
    buffer_load_dwordx2 v[204:205], v33, s[32:35], s60 offen offset:1024 sc1
    v_mfma_f32_16x16x32_bf16 v[192:195], v[48:51], v[88:91], v[192:195]
    ds_read_b128 v[152:155], v35 offset:1600
    v_mfma_f32_16x16x32_bf16 v[196:199], v[48:51], v[92:95], v[196:199]
    v_mfma_f32_16x16x32_bf16 v[180:183], v[52:55], v[72:75], v[180:183]
    ds_read_b128 v[124:127], v34 offset:2624
    buffer_load_dwordx2 v[206:207], v33, s[32:35], s60 offen offset:1536 sc1
    v_mfma_f32_16x16x32_bf16 v[184:187], v[52:55], v[76:79], v[184:187]
    v_mfma_f32_16x16x32_bf16 v[188:191], v[52:55], v[80:83], v[188:191]
    ds_read_b128 v[156:159], v35 offset:1088
    v_mfma_f32_16x16x32_bf16 v[192:195], v[52:55], v[84:87], v[192:195]
    v_mfma_f32_16x16x32_bf16 v[196:199], v[52:55], v[88:91], v[196:199]
    ds_read_b128 v[128:131], v34 offset:3136
    v_mfma_f32_16x16x32_bf16 v[184:187], v[56:59], v[72:75], v[184:187]
    v_mfma_f32_16x16x32_bf16 v[188:191], v[56:59], v[76:79], v[188:191]
    ds_read_b128 v[160:163], v35 offset:576
    v_mfma_f32_16x16x32_bf16 v[192:195], v[56:59], v[80:83], v[192:195]
    v_mfma_f32_16x16x32_bf16 v[196:199], v[56:59], v[84:87], v[196:199]
    ds_read_b128 v[132:135], v34 offset:3648
    v_mfma_f32_16x16x32_bf16 v[188:191], v[60:63], v[72:75], v[188:191]
    v_mfma_f32_16x16x32_bf16 v[192:195], v[60:63], v[76:79], v[192:195]
    s_waitcnt lgkmcnt(14)
    ds_read_b128 v[164:167], v35 offset:64
    v_mfma_f32_16x16x32_bf16 v[196:199], v[60:63], v[80:83], v[196:199]
    v_mfma_f32_16x16x32_bf16 v[192:195], v[64:67], v[72:75], v[192:195]
    v_mfma_f32_16x16x32_bf16 v[196:199], v[64:67], v[76:79], v[196:199]
    v_mfma_f32_16x16x32_bf16 v[196:199], v[68:71], v[72:75], v[196:199]
    s_waitcnt lgkmcnt(0)
    v_mfma_f32_16x16x32_bf16 v[168:171], v[104:107], v[136:139], v[168:171]
    s_add_u32 s66, s64, 0
    s_and_b32 s66, s66, 15
    s_lshl_b32 s66, s66, 10
    s_add_u32 s50, s58, s66
    buffer_load_dwordx4 a[0:3], v240, s[32:35], s50 offen offset:0 sc1
    v_mfma_f32_16x16x32_bf16 v[172:175], v[104:107], v[140:143], v[172:175]
    ds_read_b128 v[40:43], v34 offset:128
    v_mfma_f32_16x16x32_bf16 v[176:179], v[104:107], v[144:147], v[176:179]
    v_mfma_f32_16x16x32_bf16 v[180:183], v[104:107], v[148:151], v[180:183]
    ds_read_b128 v[72:75], v35 offset:3712
    v_mfma_f32_16x16x32_bf16 v[184:187], v[104:107], v[152:155], v[184:187]
    s_add_u32 s50, s58, s66
    s_add_u32 s50, s50, 16384
    buffer_load_dwordx4 a[4:7], v241, s[32:35], s50 offen offset:0 sc1
    v_mfma_f32_16x16x32_bf16 v[188:191], v[104:107], v[156:159], v[188:191]
    ds_read_b128 v[44:47], v34 offset:640
    v_mfma_f32_16x16x32_bf16 v[192:195], v[104:107], v[160:163], v[192:195]
    v_mfma_f32_16x16x32_bf16 v[196:199], v[104:107], v[164:167], v[196:199]
    ds_read_b128 v[76:79], v35 offset:3200
    v_mfma_f32_16x16x32_bf16 v[172:175], v[108:111], v[136:139], v[172:175]
    s_add_u32 s50, s59, s66
    buffer_load_dwordx4 a[8:11], v240, s[32:35], s50 offen offset:0 sc1
    v_mfma_f32_16x16x32_bf16 v[176:179], v[108:111], v[140:143], v[176:179]
    ds_read_b128 v[48:51], v34 offset:1152
    v_mfma_f32_16x16x32_bf16 v[180:183], v[108:111], v[144:147], v[180:183]
    v_mfma_f32_16x16x32_bf16 v[184:187], v[108:111], v[148:151], v[184:187]
    ds_read_b128 v[80:83], v35 offset:2688
    v_mfma_f32_16x16x32_bf16 v[188:191], v[108:111], v[152:155], v[188:191]
    s_add_u32 s50, s59, s66
    s_add_u32 s50, s50, 16384
    buffer_load_dwordx4 a[12:15], v241, s[32:35], s50 offen offset:0 sc1
    v_mfma_f32_16x16x32_bf16 v[192:195], v[108:111], v[156:159], v[192:195]
    ds_read_b128 v[52:55], v34 offset:1664
    v_mfma_f32_16x16x32_bf16 v[196:199], v[108:111], v[160:163], v[196:199]
    v_mfma_f32_16x16x32_bf16 v[176:179], v[112:115], v[136:139], v[176:179]
    ds_read_b128 v[84:87], v35 offset:2176
    v_mfma_f32_16x16x32_bf16 v[180:183], v[112:115], v[140:143], v[180:183]
    s_add_u32 s66, s64, 1
    s_and_b32 s66, s66, 15
    s_lshl_b32 s66, s66, 10
    s_add_u32 s50, s58, s66
    buffer_load_dwordx4 a[16:19], v240, s[32:35], s50 offen offset:0 sc1
    v_mfma_f32_16x16x32_bf16 v[184:187], v[112:115], v[144:147], v[184:187]
    ds_read_b128 v[56:59], v34 offset:2176
    v_mfma_f32_16x16x32_bf16 v[188:191], v[112:115], v[148:151], v[188:191]
    v_mfma_f32_16x16x32_bf16 v[192:195], v[112:115], v[152:155], v[192:195]
    ds_read_b128 v[88:91], v35 offset:1664
    v_mfma_f32_16x16x32_bf16 v[196:199], v[112:115], v[156:159], v[196:199]
    s_add_u32 s50, s58, s66
    s_add_u32 s50, s50, 16384
    buffer_load_dwordx4 a[20:23], v241, s[32:35], s50 offen offset:0 sc1
    v_mfma_f32_16x16x32_bf16 v[180:183], v[116:119], v[136:139], v[180:183]
    ds_read_b128 v[60:63], v34 offset:2688
    v_mfma_f32_16x16x32_bf16 v[184:187], v[116:119], v[140:143], v[184:187]
    v_mfma_f32_16x16x32_bf16 v[188:191], v[116:119], v[144:147], v[188:191]
    ds_read_b128 v[92:95], v35 offset:1152
    v_mfma_f32_16x16x32_bf16 v[192:195], v[116:119], v[148:151], v[192:195]
    s_add_u32 s50, s59, s66
    buffer_load_dwordx4 a[24:27], v240, s[32:35], s50 offen offset:0 sc1
    v_mfma_f32_16x16x32_bf16 v[196:199], v[116:119], v[152:155], v[196:199]
    ds_read_b128 v[64:67], v34 offset:3200
    v_mfma_f32_16x16x32_bf16 v[184:187], v[120:123], v[136:139], v[184:187]
    v_mfma_f32_16x16x32_bf16 v[188:191], v[120:123], v[140:143], v[188:191]
    ds_read_b128 v[96:99], v35 offset:640
    v_mfma_f32_16x16x32_bf16 v[192:195], v[120:123], v[144:147], v[192:195]
    s_add_u32 s50, s59, s66
    s_add_u32 s50, s50, 16384
    buffer_load_dwordx4 a[28:31], v241, s[32:35], s50 offen offset:0 sc1
    v_mfma_f32_16x16x32_bf16 v[196:199], v[120:123], v[148:151], v[196:199]
    ds_read_b128 v[68:71], v34 offset:3712
    v_mfma_f32_16x16x32_bf16 v[188:191], v[124:127], v[136:139], v[188:191]
    v_mfma_f32_16x16x32_bf16 v[192:195], v[124:127], v[140:143], v[192:195]
    s_waitcnt lgkmcnt(14)
    ds_read_b128 v[100:103], v35 offset:128
    v_mfma_f32_16x16x32_bf16 v[196:199], v[124:127], v[144:147], v[196:199]
    v_mfma_f32_16x16x32_bf16 v[192:195], v[128:131], v[136:139], v[192:195]
    v_mfma_f32_16x16x32_bf16 v[196:199], v[128:131], v[140:143], v[196:199]
    v_mfma_f32_16x16x32_bf16 v[196:199], v[132:135], v[136:139], v[196:199]
    s_waitcnt lgkmcnt(0)
    v_mfma_f32_16x16x32_bf16 v[168:171], v[40:43], v[72:75], v[168:171]
    s_add_u32 s66, s64, 2
    s_and_b32 s66, s66, 15
    s_lshl_b32 s66, s66, 10
    s_add_u32 s50, s58, s66
    buffer_load_dwordx4 a[32:35], v240, s[32:35], s50 offen offset:0 sc1
    v_mfma_f32_16x16x32_bf16 v[172:175], v[40:43], v[76:79], v[172:175]
    ds_read_b128 v[104:107], v34 offset:192
    v_mfma_f32_16x16x32_bf16 v[176:179], v[40:43], v[80:83], v[176:179]
    v_mfma_f32_16x16x32_bf16 v[180:183], v[40:43], v[84:87], v[180:183]
    ds_read_b128 v[136:139], v35 offset:3776
    v_mfma_f32_16x16x32_bf16 v[184:187], v[40:43], v[88:91], v[184:187]
    s_add_u32 s50, s58, s66
    s_add_u32 s50, s50, 16384
    buffer_load_dwordx4 a[36:39], v241, s[32:35], s50 offen offset:0 sc1
    v_mfma_f32_16x16x32_bf16 v[188:191], v[40:43], v[92:95], v[188:191]
    ds_read_b128 v[108:111], v34 offset:704
    v_mfma_f32_16x16x32_bf16 v[192:195], v[40:43], v[96:99], v[192:195]
    v_mfma_f32_16x16x32_bf16 v[196:199], v[40:43], v[100:103], v[196:199]
    ds_read_b128 v[140:143], v35 offset:3264
    v_mfma_f32_16x16x32_bf16 v[172:175], v[44:47], v[72:75], v[172:175]
    s_add_u32 s50, s59, s66
    buffer_load_dwordx4 a[40:43], v240, s[32:35], s50 offen offset:0 sc1
    v_mfma_f32_16x16x32_bf16 v[176:179], v[44:47], v[76:79], v[176:179]
    ds_read_b128 v[112:115], v34 offset:1216
    v_mfma_f32_16x16x32_bf16 v[180:183], v[44:47], v[80:83], v[180:183]
    v_mfma_f32_16x16x32_bf16 v[184:187], v[44:47], v[84:87], v[184:187]
    ds_read_b128 v[144:147], v35 offset:2752
    v_mfma_f32_16x16x32_bf16 v[188:191], v[44:47], v[88:91], v[188:191]
    s_add_u32 s50, s59, s66
    s_add_u32 s50, s50, 16384
    buffer_load_dwordx4 a[44:47], v241, s[32:35], s50 offen offset:0 sc1
    v_mfma_f32_16x16x32_bf16 v[192:195], v[44:47], v[92:95], v[192:195]
    ds_read_b128 v[116:119], v34 offset:1728
    v_mfma_f32_16x16x32_bf16 v[196:199], v[44:47], v[96:99], v[196:199]
    v_mfma_f32_16x16x32_bf16 v[176:179], v[48:51], v[72:75], v[176:179]
    ds_read_b128 v[148:151], v35 offset:2240
    v_mfma_f32_16x16x32_bf16 v[180:183], v[48:51], v[76:79], v[180:183]
    s_add_u32 s66, s64, 3
    s_and_b32 s66, s66, 15
    s_lshl_b32 s66, s66, 10
    s_add_u32 s50, s58, s66
    buffer_load_dwordx4 a[48:51], v240, s[32:35], s50 offen offset:0 sc1
    v_mfma_f32_16x16x32_bf16 v[184:187], v[48:51], v[80:83], v[184:187]
    ds_read_b128 v[120:123], v34 offset:2240
    v_mfma_f32_16x16x32_bf16 v[188:191], v[48:51], v[84:87], v[188:191]
    v_mfma_f32_16x16x32_bf16 v[192:195], v[48:51], v[88:91], v[192:195]
    ds_read_b128 v[152:155], v35 offset:1728
    v_mfma_f32_16x16x32_bf16 v[196:199], v[48:51], v[92:95], v[196:199]
    s_add_u32 s50, s58, s66
    s_add_u32 s50, s50, 16384
    buffer_load_dwordx4 a[52:55], v241, s[32:35], s50 offen offset:0 sc1
    v_mfma_f32_16x16x32_bf16 v[180:183], v[52:55], v[72:75], v[180:183]
    ds_read_b128 v[124:127], v34 offset:2752
    v_mfma_f32_16x16x32_bf16 v[184:187], v[52:55], v[76:79], v[184:187]
    v_mfma_f32_16x16x32_bf16 v[188:191], v[52:55], v[80:83], v[188:191]
    ds_read_b128 v[156:159], v35 offset:1216
    v_mfma_f32_16x16x32_bf16 v[192:195], v[52:55], v[84:87], v[192:195]
    s_add_u32 s50, s59, s66
    buffer_load_dwordx4 a[56:59], v240, s[32:35], s50 offen offset:0 sc1
    v_mfma_f32_16x16x32_bf16 v[196:199], v[52:55], v[88:91], v[196:199]
    ds_read_b128 v[128:131], v34 offset:3264
    v_mfma_f32_16x16x32_bf16 v[184:187], v[56:59], v[72:75], v[184:187]
    v_mfma_f32_16x16x32_bf16 v[188:191], v[56:59], v[76:79], v[188:191]
    ds_read_b128 v[160:163], v35 offset:704
    v_mfma_f32_16x16x32_bf16 v[192:195], v[56:59], v[80:83], v[192:195]
    s_add_u32 s50, s59, s66
    s_add_u32 s50, s50, 16384
    buffer_load_dwordx4 a[60:63], v241, s[32:35], s50 offen offset:0 sc1
    v_mfma_f32_16x16x32_bf16 v[196:199], v[56:59], v[84:87], v[196:199]
    ds_read_b128 v[132:135], v34 offset:3776
    v_mfma_f32_16x16x32_bf16 v[188:191], v[60:63], v[72:75], v[188:191]
    v_mfma_f32_16x16x32_bf16 v[192:195], v[60:63], v[76:79], v[192:195]
    s_waitcnt lgkmcnt(14)
    ds_read_b128 v[164:167], v35 offset:192
    v_mfma_f32_16x16x32_bf16 v[196:199], v[60:63], v[80:83], v[196:199]
    v_mfma_f32_16x16x32_bf16 v[192:195], v[64:67], v[72:75], v[192:195]
    v_mfma_f32_16x16x32_bf16 v[196:199], v[64:67], v[76:79], v[196:199]
    v_mfma_f32_16x16x32_bf16 v[196:199], v[68:71], v[72:75], v[196:199]
    s_waitcnt lgkmcnt(0)
    v_mfma_f32_16x16x32_bf16 v[168:171], v[104:107], v[136:139], v[168:171]
    s_add_u32 s66, s64, 4
    s_and_b32 s66, s66, 15
    s_lshl_b32 s66, s66, 10
    s_add_u32 s50, s58, s66
    buffer_load_dwordx4 a[64:67], v240, s[32:35], s50 offen offset:0 sc1
    v_mfma_f32_16x16x32_bf16 v[172:175], v[104:107], v[140:143], v[172:175]
    v_mfma_f32_16x16x32_bf16 v[176:179], v[104:107], v[144:147], v[176:179]
    v_mfma_f32_16x16x32_bf16 v[180:183], v[104:107], v[148:151], v[180:183]
    v_mfma_f32_16x16x32_bf16 v[184:187], v[104:107], v[152:155], v[184:187]
    s_add_u32 s50, s58, s66
    s_add_u32 s50, s50, 16384
    buffer_load_dwordx4 a[68:71], v241, s[32:35], s50 offen offset:0 sc1
    v_mfma_f32_16x16x32_bf16 v[188:191], v[104:107], v[156:159], v[188:191]
    v_mfma_f32_16x16x32_bf16 v[192:195], v[104:107], v[160:163], v[192:195]
    v_mfma_f32_16x16x32_bf16 v[196:199], v[104:107], v[164:167], v[196:199]
    v_mfma_f32_16x16x32_bf16 v[172:175], v[108:111], v[136:139], v[172:175]
    s_add_u32 s50, s59, s66
    buffer_load_dwordx4 a[72:75], v240, s[32:35], s50 offen offset:0 sc1
    v_mfma_f32_16x16x32_bf16 v[176:179], v[108:111], v[140:143], v[176:179]
    v_mfma_f32_16x16x32_bf16 v[180:183], v[108:111], v[144:147], v[180:183]
    v_mfma_f32_16x16x32_bf16 v[184:187], v[108:111], v[148:151], v[184:187]
    v_mfma_f32_16x16x32_bf16 v[188:191], v[108:111], v[152:155], v[188:191]
    s_add_u32 s50, s59, s66
    s_add_u32 s50, s50, 16384
    buffer_load_dwordx4 a[76:79], v241, s[32:35], s50 offen offset:0 sc1
    v_mfma_f32_16x16x32_bf16 v[192:195], v[108:111], v[156:159], v[192:195]
    v_mfma_f32_16x16x32_bf16 v[196:199], v[108:111], v[160:163], v[196:199]
    v_mfma_f32_16x16x32_bf16 v[176:179], v[112:115], v[136:139], v[176:179]
    v_mfma_f32_16x16x32_bf16 v[180:183], v[112:115], v[140:143], v[180:183]
    s_add_u32 s66, s64, 5
    s_and_b32 s66, s66, 15
    s_lshl_b32 s66, s66, 10
    s_add_u32 s50, s58, s66
    buffer_load_dwordx4 a[80:83], v240, s[32:35], s50 offen offset:0 sc1
    v_mfma_f32_16x16x32_bf16 v[184:187], v[112:115], v[144:147], v[184:187]
    v_mfma_f32_16x16x32_bf16 v[188:191], v[112:115], v[148:151], v[188:191]
    v_mfma_f32_16x16x32_bf16 v[192:195], v[112:115], v[152:155], v[192:195]
    v_mfma_f32_16x16x32_bf16 v[196:199], v[112:115], v[156:159], v[196:199]
    s_add_u32 s50, s58, s66
    s_add_u32 s50, s50, 16384
    buffer_load_dwordx4 a[84:87], v241, s[32:35], s50 offen offset:0 sc1
    v_mfma_f32_16x16x32_bf16 v[180:183], v[116:119], v[136:139], v[180:183]
    v_mfma_f32_16x16x32_bf16 v[184:187], v[116:119], v[140:143], v[184:187]
    v_mfma_f32_16x16x32_bf16 v[188:191], v[116:119], v[144:147], v[188:191]
    v_mfma_f32_16x16x32_bf16 v[192:195], v[116:119], v[148:151], v[192:195]
    s_add_u32 s50, s59, s66
    buffer_load_dwordx4 a[88:91], v240, s[32:35], s50 offen offset:0 sc1
    v_mfma_f32_16x16x32_bf16 v[196:199], v[116:119], v[152:155], v[196:199]
    v_mfma_f32_16x16x32_bf16 v[184:187], v[120:123], v[136:139], v[184:187]
    v_mfma_f32_16x16x32_bf16 v[188:191], v[120:123], v[140:143], v[188:191]
    v_mfma_f32_16x16x32_bf16 v[192:195], v[120:123], v[144:147], v[192:195]
    s_add_u32 s50, s59, s66
    s_add_u32 s50, s50, 16384
    buffer_load_dwordx4 a[92:95], v241, s[32:35], s50 offen offset:0 sc1
    v_mfma_f32_16x16x32_bf16 v[196:199], v[120:123], v[148:151], v[196:199]
    v_mfma_f32_16x16x32_bf16 v[188:191], v[124:127], v[136:139], v[188:191]
    v_mfma_f32_16x16x32_bf16 v[192:195], v[124:127], v[140:143], v[192:195]
    v_mfma_f32_16x16x32_bf16 v[196:199], v[124:127], v[144:147], v[196:199]
    v_mfma_f32_16x16x32_bf16 v[192:195], v[128:131], v[136:139], v[192:195]
    v_mfma_f32_16x16x32_bf16 v[196:199], v[128:131], v[140:143], v[196:199]
    v_mfma_f32_16x16x32_bf16 v[196:199], v[132:135], v[136:139], v[196:199]
    s_waitcnt lgkmcnt(0)
    v_lshlrev_b32 v36, 4, v1
    s_lshl_b32 s50, s3, 12
    s_add_u32 s50, s50, 114688
    v_add_u32 v37, s50, v36
    s_xor_b32 s51, s3, 1
    s_lshl_b32 s51, s51, 12
    s_add_u32 s51, s51, 114688
    v_add_u32 v38, s51, v36
    s_nop 2
    s_and_b32 s50, s3, 1
    s_cmp_eq_u32 s50, 1
    s_cbranch_scc1 hf1_19
    ds_write_b128 v37, v[184:187] offset:0
    ds_write_b128 v37, v[188:191] offset:1024
    ds_write_b128 v37, v[192:195] offset:2048
    ds_write_b128 v37, v[196:199] offset:3072
    v_mov_b32 v40, v168
    v_mov_b32 v41, v169
    v_mov_b32 v42, v170
    v_mov_b32 v43, v171
    v_mov_b32 v44, v172
    v_mov_b32 v45, v173
    v_mov_b32 v46, v174
    v_mov_b32 v47, v175
    v_mov_b32 v48, v176
    v_mov_b32 v49, v177
    v_mov_b32 v50, v178
    v_mov_b32 v51, v179
    v_mov_b32 v52, v180
    v_mov_b32 v53, v181
    v_mov_b32 v54, v182
    v_mov_b32 v55, v183
    s_branch hfd_20
hf1_19:
    ds_write_b128 v37, v[168:171] offset:0
    ds_write_b128 v37, v[172:175] offset:1024
    ds_write_b128 v37, v[176:179] offset:2048
    ds_write_b128 v37, v[180:183] offset:3072
    v_mov_b32 v40, v184
    v_mov_b32 v41, v185
    v_mov_b32 v42, v186
    v_mov_b32 v43, v187
    v_mov_b32 v44, v188
    v_mov_b32 v45, v189
    v_mov_b32 v46, v190
    v_mov_b32 v47, v191
    v_mov_b32 v48, v192
    v_mov_b32 v49, v193
    v_mov_b32 v50, v194
    v_mov_b32 v51, v195
    v_mov_b32 v52, v196
    v_mov_b32 v53, v197
    v_mov_b32 v54, v198
    v_mov_b32 v55, v199
hfd_20:
    s_add_u32 s66, s64, 6
    s_and_b32 s66, s66, 15
    s_lshl_b32 s66, s66, 10
    s_add_u32 s50, s58, s66
    buffer_load_dwordx4 a[96:99], v240, s[32:35], s50 offen offset:0 sc1
    s_add_u32 s50, s58, s66
    s_add_u32 s50, s50, 16384
    buffer_load_dwordx4 a[100:103], v241, s[32:35], s50 offen offset:0 sc1
    s_waitcnt vmcnt(30)
    s_waitcnt lgkmcnt(0)
    s_barrier
    v_and_b32 v32, 7, v27
    v_lshlrev_b32 v32, 4, v32
    v_lshl_add_u32 v32, v28, 7, v32
    v_lshrrev_b32 v33, 3, v27
    v_lshl_add_u32 v32, v33, 10, v32
    s_and_b32 s50, s3, 1
    s_lshl_b32 s50, s50, 13
    s_add_u32 s50, s50, 0x18000
    v_add_u32 v32, s50, v32
    ds_read_b128 v[208:211], v32 offset:0
    ds_read_b128 v[212:215], v32 offset:512
    ds_read_b128 v[216:219], v32 offset:2048
    ds_read_b128 v[220:223], v32 offset:2560
    ds_read_b128 v[224:227], v32 offset:4096
    ds_read_b128 v[228:231], v32 offset:4608
    ds_read_b128 v[232:235], v32 offset:6144
    ds_read_b128 v[236:239], v32 offset:6656
    s_add_u32 s50, s59, s66
    buffer_load_dwordx4 a[104:107], v240, s[32:35], s50 offen offset:0 sc1
    s_add_u32 s50, s59, s66
    s_add_u32 s50, s50, 16384
    buffer_load_dwordx4 a[108:111], v241, s[32:35], s50 offen offset:0 sc1
    ds_read_b128 v[56:59], v38 offset:0
    ds_read_b128 v[60:63], v38 offset:1024
    ds_read_b128 v[64:67], v38 offset:2048
    ds_read_b128 v[68:71], v38 offset:3072
    s_lshr_b32 s50, s3, 1
    s_mul_i32 s50, s50, 4576
    s_and_b32 s51, s3, 1
    s_lshl_b32 s51, s51, 11
    s_sub_u32 s50, s50, s51
    s_add_u32 s50, s50, 69112
    v_lshlrev_b32 v39, 5, v27
    v_lshl_add_u32 v39, v28, 3, v39
    v_sub_u32 v39, s50, v39
    ds_read_b64 v[72:73], v39 offset:1536
    ds_read_b64 v[74:75], v39 offset:1024
    ds_read_b64 v[76:77], v39 offset:512
    s_waitcnt lgkmcnt(14)
    ds_read_b64 v[78:79], v39 offset:0
    s_waitcnt lgkmcnt(4)
    v_pk_add_f32 v[40:41], v[40:41], v[56:57]
    v_pk_add_f32 v[42:43], v[42:43], v[58:59]
    v_pk_add_f32 v[44:45], v[44:45], v[60:61]
    v_pk_add_f32 v[46:47], v[46:47], v[62:63]
    v_pk_add_f32 v[48:49], v[48:49], v[64:65]
    v_pk_add_f32 v[50:51], v[50:51], v[66:67]
    v_pk_add_f32 v[52:53], v[52:53], v[68:69]
    v_pk_add_f32 v[54:55], v[54:55], v[70:71]
    s_waitcnt lgkmcnt(0)
    s_waitcnt vmcnt(28)
    v_and_b32 v80, 0xffff0000, v73
    v_lshlrev_b32 v81, 16, v73
    v_and_b32 v82, 0xffff0000, v72
    v_lshlrev_b32 v83, 16, v72
    s_add_u32 s66, s64, 7
    s_and_b32 s66, s66, 15
    s_lshl_b32 s66, s66, 10
    s_add_u32 s50, s58, s66
    buffer_load_dwordx4 a[112:115], v240, s[32:35], s50 offen offset:0 sc1
    v_lshlrev_b32 v84, 16, v200
    v_and_b32 v85, 0xffff0000, v200
    v_lshlrev_b32 v86, 16, v201
    v_and_b32 v87, 0xffff0000, v201
    v_fma_f32 v40, s56, v80, v40
    v_fma_f32 v41, s56, v81, v41
    v_fma_f32 v42, s56, v82, v42
    v_fma_f32 v43, s56, v83, v43
    s_add_u32 s50, s58, s66
    s_add_u32 s50, s50, 16384
    buffer_load_dwordx4 a[116:119], v241, s[32:35], s50 offen offset:0 sc1
    v_fma_f32 v88, v208, v84, v209
    v_fma_f32 v89, v210, v85, v211
    v_fma_f32 v90, v212, v86, v213
    v_fma_f32 v91, v214, v87, v215
    v_fma_f32 v88, v88, v40, v84
    v_fma_f32 v89, v89, v41, v85
    v_fma_f32 v90, v90, v42, v86
    v_fma_f32 v91, v91, v43, v87
    v_cvt_pk_bf16_f32 v96, v88, v89
    v_cvt_pk_bf16_f32 v97, v90, v91
    s_add_u32 s50, s59, s66
    buffer_load_dwordx4 a[120:123], v240, s[32:35], s50 offen offset:0 sc1
    v_and_b32 v80, 0xffff0000, v75
    v_lshlrev_b32 v81, 16, v75
    v_and_b32 v82, 0xffff0000, v74
    v_lshlrev_b32 v83, 16, v74
    s_add_u32 s50, s59, s66
    s_add_u32 s50, s50, 16384
    buffer_load_dwordx4 a[124:127], v241, s[32:35], s50 offen offset:0 sc1
    v_lshlrev_b32 v84, 16, v202
    v_and_b32 v85, 0xffff0000, v202
    v_lshlrev_b32 v86, 16, v203
    v_and_b32 v87, 0xffff0000, v203
    v_fma_f32 v44, s56, v80, v44
    v_fma_f32 v45, s56, v81, v45
    v_fma_f32 v46, s56, v82, v46
    v_fma_f32 v47, s56, v83, v47
    v_fma_f32 v88, v216, v84, v217
    v_fma_f32 v89, v218, v85, v219
    v_fma_f32 v90, v220, v86, v221
    v_fma_f32 v91, v222, v87, v223
    v_fma_f32 v88, v88, v44, v84
    v_fma_f32 v89, v89, v45, v85
    v_fma_f32 v90, v90, v46, v86
    v_fma_f32 v91, v91, v47, v87
    v_cvt_pk_bf16_f32 v98, v88, v89
    v_cvt_pk_bf16_f32 v99, v90, v91
    v_and_b32 v80, 0xffff0000, v77
    v_lshlrev_b32 v81, 16, v77
    v_and_b32 v82, 0xffff0000, v76
    v_lshlrev_b32 v83, 16, v76
    v_lshlrev_b32 v84, 16, v204
    v_and_b32 v85, 0xffff0000, v204
    v_lshlrev_b32 v86, 16, v205
    v_and_b32 v87, 0xffff0000, v205
    v_fma_f32 v48, s56, v80, v48
    v_fma_f32 v49, s56, v81, v49
    v_fma_f32 v50, s56, v82, v50
    v_fma_f32 v51, s56, v83, v51
    v_fma_f32 v88, v224, v84, v225
    v_fma_f32 v89, v226, v85, v227
    v_fma_f32 v90, v228, v86, v229
    v_fma_f32 v91, v230, v87, v231
    v_fma_f32 v88, v88, v48, v84
    v_fma_f32 v89, v89, v49, v85
    v_fma_f32 v90, v90, v50, v86
    v_fma_f32 v91, v91, v51, v87
    v_cvt_pk_bf16_f32 v100, v88, v89
    v_cvt_pk_bf16_f32 v101, v90, v91
    v_and_b32 v80, 0xffff0000, v79
    v_lshlrev_b32 v81, 16, v79
    v_and_b32 v82, 0xffff0000, v78
    v_lshlrev_b32 v83, 16, v78
    v_lshlrev_b32 v84, 16, v206
    v_and_b32 v85, 0xffff0000, v206
    v_lshlrev_b32 v86, 16, v207
    v_and_b32 v87, 0xffff0000, v207
    v_fma_f32 v52, s56, v80, v52
    v_fma_f32 v53, s56, v81, v53
    v_fma_f32 v54, s56, v82, v54
    v_fma_f32 v55, s56, v83, v55
    v_fma_f32 v88, v232, v84, v233
    v_fma_f32 v89, v234, v85, v235
    v_fma_f32 v90, v236, v86, v237
    v_fma_f32 v91, v238, v87, v239
    v_fma_f32 v88, v88, v52, v84
    v_fma_f32 v89, v89, v53, v85
    v_fma_f32 v90, v90, v54, v86
    v_fma_f32 v91, v91, v55, v87
    v_cvt_pk_bf16_f32 v102, v88, v89
    v_cvt_pk_bf16_f32 v103, v90, v91
    v_and_b32 v36, 1, v28
    v_lshlrev_b32 v36, 9, v36
    v_lshl_add_u32 v36, v27, 5, v36
    v_lshrrev_b32 v37, 1, v28
    v_lshl_add_u32 v36, v37, 4, v36
    s_and_b32 s50, s3, 1
    s_lshl_b32 s50, s50, 11
    s_add_u32 s50, s50, s57
    s_add_u32 s50, s50, 0x400000
    s_nop 1
    v_permlane16_swap_b32 v96, v98
    v_permlane16_swap_b32 v97, v99
    buffer_store_dwordx4 v[96:99], v36, s[32:35], s50 offen offset:0 sc1
    s_nop 1
    v_permlane16_swap_b32 v100, v102
    v_permlane16_swap_b32 v101, v103
    buffer_store_dwordx4 v[100:103], v36, s[32:35], s50 offen offset:1024 sc1
    s_add_u32 s66, s64, 8
    s_and_b32 s66, s66, 15
    s_lshl_b32 s66, s66, 10
    s_add_u32 s50, s58, s66
    buffer_load_dwordx4 a[128:131], v240, s[32:35], s50 offen offset:0 sc1
    s_add_u32 s50, s58, s66
    s_add_u32 s50, s50, 16384
    buffer_load_dwordx4 a[132:135], v241, s[32:35], s50 offen offset:0 sc1
    s_add_u32 s50, s59, s66
    buffer_load_dwordx4 a[136:139], v240, s[32:35], s50 offen offset:0 sc1
    s_add_u32 s50, s59, s66
    s_add_u32 s50, s50, 16384
    buffer_load_dwordx4 a[140:143], v241, s[32:35], s50 offen offset:0 sc1
    s_add_u32 s66, s64, 9
    s_and_b32 s66, s66, 15
    s_lshl_b32 s66, s66, 10
    s_add_u32 s50, s58, s66
    buffer_load_dwordx4 a[144:147], v240, s[32:35], s50 offen offset:0 sc1
    s_add_u32 s50, s58, s66
    s_add_u32 s50, s50, 16384
    buffer_load_dwordx4 a[148:151], v241, s[32:35], s50 offen offset:0 sc1
    s_add_u32 s50, s59, s66
    buffer_load_dwordx4 a[152:155], v240, s[32:35], s50 offen offset:0 sc1
    s_add_u32 s50, s59, s66
    s_add_u32 s50, s50, 16384
    buffer_load_dwordx4 a[156:159], v241, s[32:35], s50 offen offset:0 sc1
    s_add_u32 s66, s64, 10
    s_and_b32 s66, s66, 15
    s_lshl_b32 s66, s66, 10
    s_add_u32 s50, s58, s66
    buffer_load_dwordx4 a[160:163], v240, s[32:35], s50 offen offset:0 sc1
    s_add_u32 s50, s58, s66
    s_add_u32 s50, s50, 16384
    buffer_load_dwordx4 a[164:167], v241, s[32:35], s50 offen offset:0 sc1
    s_add_u32 s50, s59, s66
    buffer_load_dwordx4 a[168:171], v240, s[32:35], s50 offen offset:0 sc1
    s_add_u32 s50, s59, s66
    s_add_u32 s50, s50, 16384
    buffer_load_dwordx4 a[172:175], v241, s[32:35], s50 offen offset:0 sc1
    s_add_u32 s66, s64, 11
    s_and_b32 s66, s66, 15
    s_lshl_b32 s66, s66, 10
    s_add_u32 s50, s58, s66
    buffer_load_dwordx4 a[176:179], v240, s[32:35], s50 offen offset:0 sc1
    s_add_u32 s50, s58, s66
    s_add_u32 s50, s50, 16384
    buffer_load_dwordx4 a[180:183], v241, s[32:35], s50 offen offset:0 sc1
    s_waitcnt vmcnt(14)
    s_waitcnt lgkmcnt(0)
    s_barrier
    s_cmp_eq_u32 s3, 0
    s_cbranch_scc0 ga_21
    s_and_b32 s50, s2, 15
    v_lshlrev_b32 v29, 4, v1
    v_add_u32 v29, s50, v29
    v_lshlrev_b32 v29, 8, v29
    v_add_u32 v29, 0x1558000, v29
    v_mov_b32 v30, 1
    s_mov_b64 s[52:53], exec
    s_mov_b64 exec, 15
    global_atomic_add v29, v30, s[28:29] sc1
    s_mov_b64 exec, s[52:53]
ga_21:
    v_lshrrev_b32 v144, 2, v27
    v_lshl_add_u32 v145, v28, 2, v144
    v_lshlrev_b32 v145, 7, v145
    v_and_b32 v146, 1, v1
    v_lshl_add_u32 v145, v146, 3, v145
    v_bfe_u32 v146, v1, 1, 1
    v_lshl_add_u32 v145, v146, 4, v145
    v_and_b32 v146, 1, v28
    v_lshlrev_b32 v146, 2, v146
    v_lshrrev_b32 v147, 1, v144
    v_lshl_add_u32 v146, v147, 1, v146
    s_add_u32 s50, s3, 0
    s_and_b32 s50, s50, 3
    s_lshl_b32 s50, s50, 1
    v_xor_b32 v147, s50, v146
    v_lshl_add_u32 v136, v147, 4, v145
    s_add_u32 s50, s3, 1
    s_and_b32 s50, s50, 3
    s_lshl_b32 s50, s50, 1
    v_xor_b32 v147, s50, v146
    v_lshl_add_u32 v137, v147, 4, v145
    s_add_u32 s50, s3, 2
    s_and_b32 s50, s50, 3
    s_lshl_b32 s50, s50, 1
    v_xor_b32 v147, s50, v146
    v_lshl_add_u32 v138, v147, 4, v145
    s_add_u32 s50, s3, 3
    s_and_b32 s50, s50, 3
    s_lshl_b32 s50, s50, 1
    v_xor_b32 v147, s50, v146
    v_lshl_add_u32 v139, v147, 4, v145
    v_mov_b32 v140, 0x3f803f80
    v_mov_b32 v141, 0x3f803f80
    v_mov_b32 v142, 0x3f803f80
    v_mov_b32 v143, 0x3f803f80
    v_mov_b32 v244, 0x3f803f80
    v_mov_b32 v245, 0x3f803f80
    v_mov_b32 v246, 0x3f803f80
    v_mov_b32 v247, 0x3f803f80
    s_nop 1
    s_add_u32 s50, s59, s66
    buffer_load_dwordx4 a[184:187], v240, s[32:35], s50 offen offset:0 sc1
    s_add_u32 s50, s59, s66
    s_add_u32 s50, s50, 16384
    buffer_load_dwordx4 a[188:191], v241, s[32:35], s50 offen offset:0 sc1
    s_add_u32 s66, s64, 12
    s_and_b32 s66, s66, 15
    s_lshl_b32 s66, s66, 10
    s_add_u32 s50, s58, s66
    buffer_load_dwordx4 a[192:195], v240, s[32:35], s50 offen offset:0 sc1
    s_add_u32 s50, s58, s66
    s_add_u32 s50, s50, 16384
    buffer_load_dwordx4 a[196:199], v241, s[32:35], s50 offen offset:0 sc1
    v_mfma_f32_16x16x32_bf16 v[2:5], a[0:3], v[244:247], 0
    v_mfma_f32_16x16x32_bf16 v[6:9], a[4:7], v[244:247], 0
    v_mfma_f32_16x16x32_bf16 v[10:13], a[8:11], v[244:247], 0
    v_mfma_f32_16x16x32_bf16 v[14:17], a[12:15], v[244:247], 0
    s_add_u32 s50, s59, s66
    buffer_load_dwordx4 a[200:203], v240, s[32:35], s50 offen offset:0 sc1
    s_add_u32 s50, s59, s66
    s_add_u32 s50, s50, 16384
    buffer_load_dwordx4 a[204:207], v241, s[32:35], s50 offen offset:0 sc1
    s_add_u32 s66, s64, 13
    s_and_b32 s66, s66, 15
    s_lshl_b32 s66, s66, 10
    s_add_u32 s50, s58, s66
    buffer_load_dwordx4 a[208:211], v240, s[32:35], s50 offen offset:0 sc1
    s_add_u32 s50, s58, s66
    s_add_u32 s50, s50, 16384
    buffer_load_dwordx4 a[212:215], v241, s[32:35], s50 offen offset:0 sc1
    v_mfma_f32_16x16x32_bf16 v[2:5], a[16:19], v[244:247], v[2:5]
    v_mfma_f32_16x16x32_bf16 v[6:9], a[20:23], v[244:247], v[6:9]
    v_mfma_f32_16x16x32_bf16 v[10:13], a[24:27], v[244:247], v[10:13]
    v_mfma_f32_16x16x32_bf16 v[14:17], a[28:31], v[244:247], v[14:17]
    s_add_u32 s50, s59, s66
    buffer_load_dwordx4 a[216:219], v240, s[32:35], s50 offen offset:0 sc1
    s_add_u32 s50, s59, s66
    s_add_u32 s50, s50, 16384
    buffer_load_dwordx4 a[220:223], v241, s[32:35], s50 offen offset:0 sc1
    s_add_u32 s66, s64, 14
    s_and_b32 s66, s66, 15
    s_lshl_b32 s66, s66, 10
    s_add_u32 s50, s58, s66
    buffer_load_dwordx4 a[224:227], v240, s[32:35], s50 offen offset:0 sc1
    s_add_u32 s50, s58, s66
    s_add_u32 s50, s50, 16384
    buffer_load_dwordx4 a[228:231], v241, s[32:35], s50 offen offset:0 sc1
    v_mfma_f32_16x16x32_bf16 v[2:5], a[32:35], v[244:247], v[2:5]
    v_mfma_f32_16x16x32_bf16 v[6:9], a[36:39], v[244:247], v[6:9]
    v_mfma_f32_16x16x32_bf16 v[10:13], a[40:43], v[244:247], v[10:13]
    v_mfma_f32_16x16x32_bf16 v[14:17], a[44:47], v[244:247], v[14:17]
    s_add_u32 s50, s59, s66
    buffer_load_dwordx4 a[232:235], v240, s[32:35], s50 offen offset:0 sc1
    s_add_u32 s50, s59, s66
    s_add_u32 s50, s50, 16384
    buffer_load_dwordx4 a[236:239], v241, s[32:35], s50 offen offset:0 sc1
    s_add_u32 s66, s64, 15
    s_and_b32 s66, s66, 15
    s_lshl_b32 s66, s66, 10
    s_add_u32 s50, s58, s66
    buffer_load_dwordx4 a[240:243], v240, s[32:35], s50 offen offset:0 sc1
    s_add_u32 s50, s58, s66
    s_add_u32 s50, s50, 16384
    buffer_load_dwordx4 a[244:247], v241, s[32:35], s50 offen offset:0 sc1
    v_mfma_f32_16x16x32_bf16 v[2:5], a[48:51], v[244:247], v[2:5]
    v_mfma_f32_16x16x32_bf16 v[6:9], a[52:55], v[244:247], v[6:9]
    v_mfma_f32_16x16x32_bf16 v[10:13], a[56:59], v[244:247], v[10:13]
    v_mfma_f32_16x16x32_bf16 v[14:17], a[60:63], v[244:247], v[14:17]
    s_add_u32 s50, s59, s66
    buffer_load_dwordx4 a[248:251], v240, s[32:35], s50 offen offset:0 sc1
    s_add_u32 s50, s59, s66
    s_add_u32 s50, s50, 16384
    buffer_load_dwordx4 a[252:255], v241, s[32:35], s50 offen offset:0 sc1
    v_mfma_f32_16x16x32_bf16 v[2:5], a[64:67], v[244:247], v[2:5]
    v_mfma_f32_16x16x32_bf16 v[6:9], a[68:71], v[244:247], v[6:9]
    v_mfma_f32_16x16x32_bf16 v[10:13], a[72:75], v[244:247], v[10:13]
    v_mfma_f32_16x16x32_bf16 v[14:17], a[76:79], v[244:247], v[14:17]
    v_mfma_f32_16x16x32_bf16 v[2:5], a[80:83], v[244:247], v[2:5]
    v_mfma_f32_16x16x32_bf16 v[6:9], a[84:87], v[244:247], v[6:9]
    v_mfma_f32_16x16x32_bf16 v[10:13], a[88:91], v[244:247], v[10:13]
    v_mfma_f32_16x16x32_bf16 v[14:17], a[92:95], v[244:247], v[14:17]
    v_mfma_f32_16x16x32_bf16 v[2:5], a[96:99], v[244:247], v[2:5]
    v_mfma_f32_16x16x32_bf16 v[6:9], a[100:103], v[244:247], v[6:9]
    v_mfma_f32_16x16x32_bf16 v[10:13], a[104:107], v[244:247], v[10:13]
    v_mfma_f32_16x16x32_bf16 v[14:17], a[108:111], v[244:247], v[14:17]
    v_mfma_f32_16x16x32_bf16 v[2:5], a[112:115], v[244:247], v[2:5]
    v_mfma_f32_16x16x32_bf16 v[6:9], a[116:119], v[244:247], v[6:9]
    v_mfma_f32_16x16x32_bf16 v[10:13], a[120:123], v[244:247], v[10:13]
    v_mfma_f32_16x16x32_bf16 v[14:17], a[124:127], v[244:247], v[14:17]
    v_lshrrev_b32 v212, 3, v1
    v_lshlrev_b32 v212, 12, v212
    v_and_b32 v213, 7, v1
    v_xor_b32 v213, v213, v28
    v_xor_b32 v214, 4, v213
    v_lshl_add_u32 v213, v213, 4, v212
    v_lshl_add_u32 v214, v214, 4, v212
    s_add_u32 s50, s3, 0
    s_and_b32 s50, s50, 3
    s_lshl_b32 s50, s50, 16
    s_add_u32 s50, s50, 0
    v_add_u32 v200, s50, v213
    s_add_u32 s50, s3, 0
    s_and_b32 s50, s50, 3
    s_lshl_b32 s50, s50, 16
    s_add_u32 s50, s50, 32768
    v_add_u32 v201, s50, v214
    s_add_u32 s50, s3, 1
    s_and_b32 s50, s50, 3
    s_lshl_b32 s50, s50, 16
    s_add_u32 s50, s50, 0
    v_add_u32 v202, s50, v213
    s_add_u32 s50, s3, 1
    s_and_b32 s50, s50, 3
    s_lshl_b32 s50, s50, 16
    s_add_u32 s50, s50, 32768
    v_add_u32 v203, s50, v214
    s_add_u32 s50, s3, 2
    s_and_b32 s50, s50, 3
    s_lshl_b32 s50, s50, 16
    s_add_u32 s50, s50, 0
    v_add_u32 v204, s50, v213
    s_add_u32 s50, s3, 2
    s_and_b32 s50, s50, 3
    s_lshl_b32 s50, s50, 16
    s_add_u32 s50, s50, 32768
    v_add_u32 v205, s50, v214
    s_add_u32 s50, s3, 3
    s_and_b32 s50, s50, 3
    s_lshl_b32 s50, s50, 16
    s_add_u32 s50, s50, 0
    v_add_u32 v206, s50, v213
    s_add_u32 s50, s3, 3
    s_and_b32 s50, s50, 3
    s_lshl_b32 s50, s50, 16
    s_add_u32 s50, s50, 32768
    v_add_u32 v207, s50, v214
    s_mul_i32 s56, s3, 24576
    s_add_u32 s56, s56, 65536
    v_lshrrev_b32 v213, 1, v27
    v_lshrrev_b32 v214, 1, v28
    v_xor_b32 v213, v213, v214
    v_and_b32 v214, 1, v28
    v_lshlrev_b32 v214, 3, v214
    v_lshl_add_u32 v214, v27, 7, v214
    v_add_u32 v214, s56, v214
    v_xor_b32 v215, 0, v213
    v_lshl_add_u32 v208, v215, 4, v214
    v_xor_b32 v215, 2, v213
    v_lshl_add_u32 v209, v215, 4, v214
    v_xor_b32 v215, 4, v213
    v_lshl_add_u32 v210, v215, 4, v214
    v_xor_b32 v215, 6, v213
    v_lshl_add_u32 v211, v215, 4, v214
    s_lshl_b32 s57, s3, 10
    s_lshl_b32 s50, s48, 18
    s_add_u32 s40, s18, s50
    s_addc_u32 s41, s19, 0
    s_mov_b32 s42, 0x40000
    s_mov_b32 s43, 0x20000
    s_cmp_eq_u32 s3, 0
    s_cbranch_scc0 gp_22
    s_lshr_b32 s50, s2, 4
    s_and_b32 s50, s50, 3
    s_lshl_b32 s50, s50, 4
    v_add_u32 v29, s50, v1
    v_lshlrev_b32 v29, 8, v29
    v_add_u32 v29, 0x1558000, v29
    s_mov_b64 s[52:53], exec
    s_mov_b64 exec, 0xffff
    global_load_dword v30, v29, s[28:29] sc1
    s_mov_b32 s51, 0
gl_23:
    s_waitcnt vmcnt(0)
    v_cmp_gt_u32 vcc, 16, v30
    s_nop 1
    s_cmp_eq_u64 vcc, 0
    s_cbranch_scc1 gd_24
    global_load_dword v30, v29, s[28:29] sc1
    s_add_u32 s51, s51, 1
    s_cmp_lt_u32 s51, 0x200000
    s_cbranch_scc1 gl_23
    s_waitcnt vmcnt(0)
gd_24:
    s_mov_b64 exec, s[52:53]
gp_22:
    s_barrier
    v_lshrrev_b32 v148, 3, v1
    v_lshlrev_b32 v148, 12, v148
    v_and_b32 v149, 7, v1
    v_lshlrev_b32 v150, 1, v28
    v_xor_b32 v149, v149, v150
    v_lshl_add_u32 v148, v149, 4, v148
    s_lshl_b32 s60, s48, 7
    s_add_u32 s60, s60, 0x400000
    s_lshl_b32 s61, s3, 12
    s_add_u32 s62, s3, 0
    s_add_u32 s62, s62, s64
    s_and_b32 s62, s62, 15
    s_lshl_b32 s62, s62, 17
    s_add_u32 s62, s62, s60
    s_add_u32 s50, s62, 0x0
    s_add_u32 m0, s61, 0x0
    s_nop 0
    buffer_load_dwordx4 v148, s[32:35], s50 offen sc1 lds
    s_add_u32 s50, s62, 0x8000
    s_add_u32 m0, s61, 0x400
    s_nop 0
    buffer_load_dwordx4 v148, s[32:35], s50 offen sc1 lds
    s_add_u32 s50, s62, 0x10000
    s_add_u32 m0, s61, 0x800
    s_nop 0
    buffer_load_dwordx4 v148, s[32:35], s50 offen sc1 lds
    s_add_u32 s50, s62, 0x18000
    s_add_u32 m0, s61, 0xc00
    s_nop 0
    buffer_load_dwordx4 v148, s[32:35], s50 offen sc1 lds
    s_add_u32 s62, s3, 4
    s_add_u32 s62, s62, s64
    s_and_b32 s62, s62, 15
    s_lshl_b32 s62, s62, 17
    s_add_u32 s62, s62, s60
    s_add_u32 s50, s62, 0x0
    s_add_u32 m0, s61, 0x4000
    s_nop 0
    buffer_load_dwordx4 v148, s[32:35], s50 offen sc1 lds
    s_add_u32 s50, s62, 0x8000
    s_add_u32 m0, s61, 0x4400
    s_nop 0
    buffer_load_dwordx4 v148, s[32:35], s50 offen sc1 lds
    s_add_u32 s50, s62, 0x10000
    s_add_u32 m0, s61, 0x4800
    s_nop 0
    buffer_load_dwordx4 v148, s[32:35], s50 offen sc1 lds
    s_add_u32 s50, s62, 0x18000
    s_add_u32 m0, s61, 0x4c00
    s_nop 0
    buffer_load_dwordx4 v148, s[32:35], s50 offen sc1 lds
    s_waitcnt vmcnt(8)
    v_mfma_f32_16x16x32_bf16 v[2:5], a[128:131], v[244:247], v[2:5]
    v_mfma_f32_16x16x32_bf16 v[6:9], a[132:135], v[244:247], v[6:9]
    v_mfma_f32_16x16x32_bf16 v[10:13], a[136:139], v[244:247], v[10:13]
    v_mfma_f32_16x16x32_bf16 v[14:17], a[140:143], v[244:247], v[14:17]
    v_mfma_f32_16x16x32_bf16 v[2:5], a[144:147], v[244:247], v[2:5]
    v_mfma_f32_16x16x32_bf16 v[6:9], a[148:151], v[244:247], v[6:9]
    v_mfma_f32_16x16x32_bf16 v[10:13], a[152:155], v[244:247], v[10:13]
    v_mfma_f32_16x16x32_bf16 v[14:17], a[156:159], v[244:247], v[14:17]
    v_mfma_f32_16x16x32_bf16 v[2:5], a[160:163], v[244:247], v[2:5]
    v_mfma_f32_16x16x32_bf16 v[6:9], a[164:167], v[244:247], v[6:9]
    v_mfma_f32_16x16x32_bf16 v[10:13], a[168:171], v[244:247], v[10:13]
    v_mfma_f32_16x16x32_bf16 v[14:17], a[172:175], v[244:247], v[14:17]
    v_mfma_f32_16x16x32_bf16 v[2:5], a[176:179], v[244:247], v[2:5]
    v_mfma_f32_16x16x32_bf16 v[6:9], a[180:183], v[244:247], v[6:9]
    v_mfma_f32_16x16x32_bf16 v[10:13], a[184:187], v[244:247], v[10:13]
    v_mfma_f32_16x16x32_bf16 v[14:17], a[188:191], v[244:247], v[14:17]
    v_mfma_f32_16x16x32_bf16 v[2:5], a[192:195], v[244:247], v[2:5]
    v_mfma_f32_16x16x32_bf16 v[6:9], a[196:199], v[244:247], v[6:9]
    v_mfma_f32_16x16x32_bf16 v[10:13], a[200:203], v[244:247], v[10:13]
    v_mfma_f32_16x16x32_bf16 v[14:17], a[204:207], v[244:247], v[14:17]
    v_mfma_f32_16x16x32_bf16 v[2:5], a[208:211], v[244:247], v[2:5]
    v_mfma_f32_16x16x32_bf16 v[6:9], a[212:215], v[244:247], v[6:9]
    v_mfma_f32_16x16x32_bf16 v[10:13], a[216:219], v[244:247], v[10:13]
    v_mfma_f32_16x16x32_bf16 v[14:17], a[220:223], v[244:247], v[14:17]
    v_mfma_f32_16x16x32_bf16 v[2:5], a[224:227], v[244:247], v[2:5]
    v_mfma_f32_16x16x32_bf16 v[6:9], a[228:231], v[244:247], v[6:9]
    v_mfma_f32_16x16x32_bf16 v[10:13], a[232:235], v[244:247], v[10:13]
    v_mfma_f32_16x16x32_bf16 v[14:17], a[236:239], v[244:247], v[14:17]
    v_mfma_f32_16x16x32_bf16 v[2:5], a[240:243], v[244:247], v[2:5]
    v_mfma_f32_16x16x32_bf16 v[6:9], a[244:247], v[244:247], v[6:9]
    v_mfma_f32_16x16x32_bf16 v[10:13], a[248:251], v[244:247], v[10:13]
    v_mfma_f32_16x16x32_bf16 v[14:17], a[252:255], v[244:247], v[14:17]
    s_waitcnt vmcnt(4)
    s_waitcnt lgkmcnt(0)
    s_barrier
    ds_read_b64_tr_b16 v[96:97], v136 offset:0
    ds_read_b64_tr_b16 v[98:99], v136 offset:2048
    ds_read_b64_tr_b16 v[100:101], v137 offset:0
    ds_read_b64_tr_b16 v[102:103], v137 offset:2048
    ds_read_b64_tr_b16 v[104:105], v138 offset:0
    ds_read_b64_tr_b16 v[106:107], v138 offset:2048
    ds_read_b64_tr_b16 v[108:109], v139 offset:0
    ds_read_b64_tr_b16 v[110:111], v139 offset:2048
    s_waitcnt lgkmcnt(0)
    v_mfma_f32_16x16x32_bf16 v[32:35], a[0:3], v[96:99], 0
    ds_read_b64_tr_b16 v[112:113], v136 offset:4096
    v_mfma_f32_16x16x32_bf16 v[36:39], a[0:3], v[100:103], 0
    ds_read_b64_tr_b16 v[114:115], v136 offset:6144
    s_add_u32 s62, s3, 8
    s_add_u32 s62, s62, s64
    s_and_b32 s62, s62, 15
    s_lshl_b32 s62, s62, 17
    s_add_u32 s62, s62, s60
    s_add_u32 s50, s62, 0x0
    s_add_u32 m0, s61, 0x8000
    s_nop 0
    buffer_load_dwordx4 v148, s[32:35], s50 offen sc1 lds
    v_mfma_f32_16x16x32_bf16 v[40:43], a[0:3], v[104:107], 0
    ds_read_b64_tr_b16 v[116:117], v137 offset:4096
    v_mfma_f32_16x16x32_bf16 v[44:47], a[0:3], v[108:111], 0
    ds_read_b64_tr_b16 v[118:119], v137 offset:6144
    v_mfma_f32_16x16x32_bf16 v[48:51], a[4:7], v[96:99], 0
    ds_read_b64_tr_b16 v[120:121], v138 offset:4096
    v_mfma_f32_16x16x32_bf16 v[52:55], a[4:7], v[100:103], 0
    ds_read_b64_tr_b16 v[122:123], v138 offset:6144
    s_add_u32 s50, s62, 0x8000
    s_add_u32 m0, s61, 0x8400
    s_nop 0
    buffer_load_dwordx4 v148, s[32:35], s50 offen sc1 lds
    v_mfma_f32_16x16x32_bf16 v[56:59], a[4:7], v[104:107], 0
    ds_read_b64_tr_b16 v[124:125], v139 offset:4096
    v_mfma_f32_16x16x32_bf16 v[60:63], a[4:7], v[108:111], 0
    ds_read_b64_tr_b16 v[126:127], v139 offset:6144
    v_mfma_f32_16x16x32_bf16 v[64:67], a[8:11], v[96:99], 0
    v_mfma_f32_16x16x32_bf16 v[68:71], a[8:11], v[100:103], 0
    s_add_u32 s50, s62, 0x10000
    s_add_u32 m0, s61, 0x8800
    s_nop 0
    buffer_load_dwordx4 v148, s[32:35], s50 offen sc1 lds
    v_mfma_f32_16x16x32_bf16 v[72:75], a[8:11], v[104:107], 0
    v_mfma_f32_16x16x32_bf16 v[76:79], a[8:11], v[108:111], 0
    v_mfma_f32_16x16x32_bf16 v[80:83], a[12:15], v[96:99], 0
    v_mfma_f32_16x16x32_bf16 v[84:87], a[12:15], v[100:103], 0
    s_add_u32 s50, s62, 0x18000
    s_add_u32 m0, s61, 0x8c00
    s_nop 0
    buffer_load_dwordx4 v148, s[32:35], s50 offen sc1 lds
    v_mfma_f32_16x16x32_bf16 v[88:91], a[12:15], v[104:107], 0
    v_mfma_f32_16x16x32_bf16 v[92:95], a[12:15], v[108:111], 0
    s_waitcnt lgkmcnt(0)
    v_mfma_f32_16x16x32_bf16 v[32:35], a[16:19], v[112:115], v[32:35]
    ds_read_b64_tr_b16 v[96:97], v136 offset:8192
    v_mfma_f32_16x16x32_bf16 v[36:39], a[16:19], v[116:119], v[36:39]
    ds_read_b64_tr_b16 v[98:99], v136 offset:10240
    s_add_u32 s62, s3, 12
    s_add_u32 s62, s62, s64
    s_and_b32 s62, s62, 15
    s_lshl_b32 s62, s62, 17
    s_add_u32 s62, s62, s60
    s_add_u32 s50, s62, 0x0
    s_add_u32 m0, s61, 0xc000
    s_nop 0
    buffer_load_dwordx4 v148, s[32:35], s50 offen sc1 lds
    v_mfma_f32_16x16x32_bf16 v[40:43], a[16:19], v[120:123], v[40:43]
    ds_read_b64_tr_b16 v[100:101], v137 offset:8192
    v_mfma_f32_16x16x32_bf16 v[44:47], a[16:19], v[124:127], v[44:47]
    ds_read_b64_tr_b16 v[102:103], v137 offset:10240
    v_mfma_f32_16x16x32_bf16 v[48:51], a[20:23], v[112:115], v[48:51]
    ds_read_b64_tr_b16 v[104:105], v138 offset:8192
    v_mfma_f32_16x16x32_bf16 v[52:55], a[20:23], v[116:119], v[52:55]
    ds_read_b64_tr_b16 v[106:107], v138 offset:10240
    s_add_u32 s50, s62, 0x8000
    s_add_u32 m0, s61, 0xc400
    s_nop 0
    buffer_load_dwordx4 v148, s[32:35], s50 offen sc1 lds
    v_mfma_f32_16x16x32_bf16 v[56:59], a[20:23], v[120:123], v[56:59]
    ds_read_b64_tr_b16 v[108:109], v139 offset:8192
    v_mfma_f32_16x16x32_bf16 v[60:63], a[20:23], v[124:127], v[60:63]
    ds_read_b64_tr_b16 v[110:111], v139 offset:10240
    v_mfma_f32_16x16x32_bf16 v[64:67], a[24:27], v[112:115], v[64:67]
    v_mfma_f32_16x16x32_bf16 v[68:71], a[24:27], v[116:119], v[68:71]
    s_add_u32 s50, s62, 0x10000
    s_add_u32 m0, s61, 0xc800
    s_nop 0
    buffer_load_dwordx4 v148, s[32:35], s50 offen sc1 lds
    v_mfma_f32_16x16x32_bf16 v[72:75], a[24:27], v[120:123], v[72:75]
    v_mfma_f32_16x16x32_bf16 v[76:79], a[24:27], v[124:127], v[76:79]
    v_mfma_f32_16x16x32_bf16 v[80:83], a[28:31], v[112:115], v[80:83]
    v_mfma_f32_16x16x32_bf16 v[84:87], a[28:31], v[116:119], v[84:87]
    s_add_u32 s50, s62, 0x18000
    s_add_u32 m0, s61, 0xcc00
    s_nop 0
    buffer_load_dwordx4 v148, s[32:35], s50 offen sc1 lds
    v_mfma_f32_16x16x32_bf16 v[88:91], a[28:31], v[120:123], v[88:91]
    v_mfma_f32_16x16x32_bf16 v[92:95], a[28:31], v[124:127], v[92:95]
    s_lshl_b32 s50, s48, 18
    s_and_b32 s51, s49, 3
    s_lshl_b32 s51, s51, 16
    s_add_u32 s50, s50, s51
    s_lshl_b32 s51, s3, 10
    s_add_u32 s50, s50, s51
    s_mov_b32 s44, s18
    s_mov_b32 s45, s19
    s_mov_b32 s46, 0x800000
    s_mov_b32 s47, 0x20000
    s_lshr_b32 s51, s68, 1
    s_add_u32 s51, s51, 0
    v_add_u32 v146, s51, v28
    v_and_b32 v146, 7, v146
    v_lshlrev_b32 v145, 12, v27
    v_lshl_add_u32 v145, v146, 7, v145
    v_cmp_gt_u32 vcc, 4, v28
    v_mov_b32 v146, 0x40000000
    s_nop 0
    v_cndmask_b32 v145, v146, v145, vcc
    buffer_load_dword v26, v145, s[44:47], s50 offen offset:0
    s_lshl_b32 s50, s48, 18
    s_and_b32 s51, s49, 3
    s_lshl_b32 s51, s51, 16
    s_add_u32 s50, s50, s51
    s_lshl_b32 s51, s3, 10
    s_add_u32 s50, s50, s51
    s_mov_b32 s44, s18
    s_mov_b32 s45, s19
    s_mov_b32 s46, 0x800000
    s_mov_b32 s47, 0x20000
    s_lshr_b32 s51, s68, 1
    s_add_u32 s51, s51, 4
    v_add_u32 v146, s51, v28
    v_and_b32 v146, 7, v146
    v_lshlrev_b32 v145, 12, v27
    v_lshl_add_u32 v145, v146, 7, v145
    v_cmp_gt_u32 vcc, 4, v28
    v_mov_b32 v146, 0x40000000
    s_nop 0
    v_cndmask_b32 v145, v146, v145, vcc
    buffer_load_dword v26, v145, s[44:47], s50 offen offset:0
    s_waitcnt lgkmcnt(0)
    v_mfma_f32_16x16x32_bf16 v[32:35], a[32:35], v[96:99], v[32:35]
    ds_read_b64_tr_b16 v[112:113], v136 offset:12288
    v_mfma_f32_16x16x32_bf16 v[36:39], a[32:35], v[100:103], v[36:39]
    ds_read_b64_tr_b16 v[114:115], v136 offset:14336
    v_mfma_f32_16x16x32_bf16 v[40:43], a[32:35], v[104:107], v[40:43]
    ds_read_b64_tr_b16 v[116:117], v137 offset:12288
    v_mfma_f32_16x16x32_bf16 v[44:47], a[32:35], v[108:111], v[44:47]
    ds_read_b64_tr_b16 v[118:119], v137 offset:14336
    v_mfma_f32_16x16x32_bf16 v[48:51], a[36:39], v[96:99], v[48:51]
    ds_read_b64_tr_b16 v[120:121], v138 offset:12288
    v_mfma_f32_16x16x32_bf16 v[52:55], a[36:39], v[100:103], v[52:55]
    ds_read_b64_tr_b16 v[122:123], v138 offset:14336
    v_mfma_f32_16x16x32_bf16 v[56:59], a[36:39], v[104:107], v[56:59]
    ds_read_b64_tr_b16 v[124:125], v139 offset:12288
    v_mfma_f32_16x16x32_bf16 v[60:63], a[36:39], v[108:111], v[60:63]
    ds_read_b64_tr_b16 v[126:127], v139 offset:14336
    v_mfma_f32_16x16x32_bf16 v[64:67], a[40:43], v[96:99], v[64:67]
    v_mfma_f32_16x16x32_bf16 v[68:71], a[40:43], v[100:103], v[68:71]
    v_mfma_f32_16x16x32_bf16 v[72:75], a[40:43], v[104:107], v[72:75]
    v_mfma_f32_16x16x32_bf16 v[76:79], a[40:43], v[108:111], v[76:79]
    v_mfma_f32_16x16x32_bf16 v[80:83], a[44:47], v[96:99], v[80:83]
    v_mfma_f32_16x16x32_bf16 v[84:87], a[44:47], v[100:103], v[84:87]
    v_mfma_f32_16x16x32_bf16 v[88:91], a[44:47], v[104:107], v[88:91]
    v_mfma_f32_16x16x32_bf16 v[92:95], a[44:47], v[108:111], v[92:95]
    s_waitcnt vmcnt(2)
    s_barrier
    s_waitcnt lgkmcnt(0)
    v_mfma_f32_16x16x32_bf16 v[32:35], a[48:51], v[112:115], v[32:35]
    ds_read_b64_tr_b16 v[96:97], v136 offset:16384
    v_mfma_f32_16x16x32_bf16 v[36:39], a[48:51], v[116:119], v[36:39]
    ds_read_b64_tr_b16 v[98:99], v136 offset:18432
    v_mfma_f32_16x16x32_bf16 v[40:43], a[48:51], v[120:123], v[40:43]
    ds_read_b64_tr_b16 v[100:101], v137 offset:16384
    v_mfma_f32_16x16x32_bf16 v[44:47], a[48:51], v[124:127], v[44:47]
    ds_read_b64_tr_b16 v[102:103], v137 offset:18432
    v_mfma_f32_16x16x32_bf16 v[48:51], a[52:55], v[112:115], v[48:51]
    ds_read_b64_tr_b16 v[104:105], v138 offset:16384
    v_mfma_f32_16x16x32_bf16 v[52:55], a[52:55], v[116:119], v[52:55]
    ds_read_b64_tr_b16 v[106:107], v138 offset:18432
    v_mfma_f32_16x16x32_bf16 v[56:59], a[52:55], v[120:123], v[56:59]
    ds_read_b64_tr_b16 v[108:109], v139 offset:16384
    v_mfma_f32_16x16x32_bf16 v[60:63], a[52:55], v[124:127], v[60:63]
    ds_read_b64_tr_b16 v[110:111], v139 offset:18432
    v_mfma_f32_16x16x32_bf16 v[64:67], a[56:59], v[112:115], v[64:67]
    ds_read_b64_tr_b16 v[164:165], v136 offset:0
    v_mfma_f32_16x16x32_bf16 v[68:71], a[56:59], v[116:119], v[68:71]
    ds_read_b64_tr_b16 v[166:167], v136 offset:2048
    v_mfma_f32_16x16x32_bf16 v[72:75], a[56:59], v[120:123], v[72:75]
    ds_read_b64_tr_b16 v[168:169], v136 offset:4096
    v_mfma_f32_16x16x32_bf16 v[76:79], a[56:59], v[124:127], v[76:79]
    ds_read_b64_tr_b16 v[170:171], v136 offset:6144
    v_mfma_f32_16x16x32_bf16 v[80:83], a[60:63], v[112:115], v[80:83]
    ds_read_b64_tr_b16 v[172:173], v136 offset:8192
    v_mfma_f32_16x16x32_bf16 v[84:87], a[60:63], v[116:119], v[84:87]
    ds_read_b64_tr_b16 v[174:175], v136 offset:10240
    v_mfma_f32_16x16x32_bf16 v[88:91], a[60:63], v[120:123], v[88:91]
    ds_read_b64_tr_b16 v[176:177], v136 offset:12288
    v_mfma_f32_16x16x32_bf16 v[92:95], a[60:63], v[124:127], v[92:95]
    s_waitcnt lgkmcnt(14)
    ds_read_b64_tr_b16 v[178:179], v136 offset:14336
    s_waitcnt lgkmcnt(8)
    s_waitcnt lgkmcnt(0)
    v_mfma_f32_16x16x32_bf16 v[32:35], a[64:67], v[96:99], v[32:35]
    ds_read_b64_tr_b16 v[112:113], v136 offset:20480
    v_mfma_f32_16x16x32_bf16 v[36:39], a[64:67], v[100:103], v[36:39]
    ds_read_b64_tr_b16 v[114:115], v136 offset:22528
    v_mfma_f32_16x16x32_bf16 v[40:43], a[64:67], v[104:107], v[40:43]
    ds_read_b64_tr_b16 v[116:117], v137 offset:20480
    v_mfma_f32_16x16x32_bf16 v[44:47], a[64:67], v[108:111], v[44:47]
    ds_read_b64_tr_b16 v[118:119], v137 offset:22528
    v_mfma_f32_16x16x32_bf16 v[48:51], a[68:71], v[96:99], v[48:51]
    ds_read_b64_tr_b16 v[120:121], v138 offset:20480
    v_mfma_f32_16x16x32_bf16 v[52:55], a[68:71], v[100:103], v[52:55]
    ds_read_b64_tr_b16 v[122:123], v138 offset:22528
    v_mfma_f32_16x16x32_bf16 v[56:59], a[68:71], v[104:107], v[56:59]
    ds_read_b64_tr_b16 v[124:125], v139 offset:20480
    v_mfma_f32_16x16x32_bf16 v[60:63], a[68:71], v[108:111], v[60:63]
    ds_read_b64_tr_b16 v[126:127], v139 offset:22528
    v_mfma_f32_16x16x32_bf16 v[64:67], a[72:75], v[96:99], v[64:67]
    ds_read_b64_tr_b16 v[180:181], v136 offset:16384
    v_mfma_f32_16x16x32_bf16 v[68:71], a[72:75], v[100:103], v[68:71]
    ds_read_b64_tr_b16 v[182:183], v136 offset:18432
    v_mfma_f32_16x16x32_bf16 v[72:75], a[72:75], v[104:107], v[72:75]
    ds_read_b64_tr_b16 v[184:185], v136 offset:20480
    v_mfma_f32_16x16x32_bf16 v[76:79], a[72:75], v[108:111], v[76:79]
    ds_read_b64_tr_b16 v[186:187], v136 offset:22528
    v_mfma_f32_16x16x32_bf16 v[80:83], a[76:79], v[96:99], v[80:83]
    ds_read_b64_tr_b16 v[188:189], v136 offset:24576
    v_mfma_f32_16x16x32_bf16 v[84:87], a[76:79], v[100:103], v[84:87]
    ds_read_b64_tr_b16 v[190:191], v136 offset:26624
    v_mfma_f32_16x16x32_bf16 v[88:91], a[76:79], v[104:107], v[88:91]
    ds_read_b64_tr_b16 v[192:193], v136 offset:28672
    v_mfma_f32_16x16x32_bf16 v[92:95], a[76:79], v[108:111], v[92:95]
    s_waitcnt lgkmcnt(14)
    ds_read_b64_tr_b16 v[194:195], v136 offset:30720
    v_mfma_f32_16x16x32_bf16 v[128:131], v[140:143], v[164:167], 0
    v_mfma_f32_16x16x32_bf16 v[132:135], v[164:167], v[164:167], 0
    v_mfma_f32_16x16x32_bf16 v[128:131], v[140:143], v[168:171], v[128:131]
    v_mfma_f32_16x16x32_bf16 v[132:135], v[168:171], v[168:171], v[132:135]
    v_mfma_f32_16x16x32_bf16 v[128:131], v[140:143], v[172:175], v[128:131]
    v_mfma_f32_16x16x32_bf16 v[132:135], v[172:175], v[172:175], v[132:135]
    v_mfma_f32_16x16x32_bf16 v[128:131], v[140:143], v[176:179], v[128:131]
    v_mfma_f32_16x16x32_bf16 v[132:135], v[176:179], v[176:179], v[132:135]
    s_waitcnt lgkmcnt(8)
    s_waitcnt lgkmcnt(0)
    v_mfma_f32_16x16x32_bf16 v[32:35], a[80:83], v[112:115], v[32:35]
    ds_read_b64_tr_b16 v[96:97], v136 offset:24576
    v_mfma_f32_16x16x32_bf16 v[36:39], a[80:83], v[116:119], v[36:39]
    ds_read_b64_tr_b16 v[98:99], v136 offset:26624
    v_mfma_f32_16x16x32_bf16 v[40:43], a[80:83], v[120:123], v[40:43]
    ds_read_b64_tr_b16 v[100:101], v137 offset:24576
    v_mfma_f32_16x16x32_bf16 v[44:47], a[80:83], v[124:127], v[44:47]
    ds_read_b64_tr_b16 v[102:103], v137 offset:26624
    v_mfma_f32_16x16x32_bf16 v[48:51], a[84:87], v[112:115], v[48:51]
    ds_read_b64_tr_b16 v[104:105], v138 offset:24576
    v_mfma_f32_16x16x32_bf16 v[52:55], a[84:87], v[116:119], v[52:55]
    ds_read_b64_tr_b16 v[106:107], v138 offset:26624
    v_mfma_f32_16x16x32_bf16 v[56:59], a[84:87], v[120:123], v[56:59]
    ds_read_b64_tr_b16 v[108:109], v139 offset:24576
    v_mfma_f32_16x16x32_bf16 v[60:63], a[84:87], v[124:127], v[60:63]
    ds_read_b64_tr_b16 v[110:111], v139 offset:26624
    v_mfma_f32_16x16x32_bf16 v[64:67], a[88:91], v[112:115], v[64:67]
    ds_read_b64_tr_b16 v[164:165], v136 offset:32768
    v_mfma_f32_16x16x32_bf16 v[68:71], a[88:91], v[116:119], v[68:71]
    ds_read_b64_tr_b16 v[166:167], v136 offset:34816
    v_mfma_f32_16x16x32_bf16 v[72:75], a[88:91], v[120:123], v[72:75]
    ds_read_b64_tr_b16 v[168:169], v136 offset:36864
    v_mfma_f32_16x16x32_bf16 v[76:79], a[88:91], v[124:127], v[76:79]
    ds_read_b64_tr_b16 v[170:171], v136 offset:38912
    v_mfma_f32_16x16x32_bf16 v[80:83], a[92:95], v[112:115], v[80:83]
    ds_read_b64_tr_b16 v[172:173], v136 offset:40960
    v_mfma_f32_16x16x32_bf16 v[84:87], a[92:95], v[116:119], v[84:87]
    ds_read_b64_tr_b16 v[174:175], v136 offset:43008
    v_mfma_f32_16x16x32_bf16 v[88:91], a[92:95], v[120:123], v[88:91]
    ds_read_b64_tr_b16 v[176:177], v136 offset:45056
    v_mfma_f32_16x16x32_bf16 v[92:95], a[92:95], v[124:127], v[92:95]
    s_waitcnt lgkmcnt(14)
    ds_read_b64_tr_b16 v[178:179], v136 offset:47104
    v_mfma_f32_16x16x32_bf16 v[128:131], v[140:143], v[180:183], v[128:131]
    v_mfma_f32_16x16x32_bf16 v[132:135], v[180:183], v[180:183], v[132:135]
    v_mfma_f32_16x16x32_bf16 v[128:131], v[140:143], v[184:187], v[128:131]
    v_mfma_f32_16x16x32_bf16 v[132:135], v[184:187], v[184:187], v[132:135]
    v_mfma_f32_16x16x32_bf16 v[128:131], v[140:143], v[188:191], v[128:131]
    v_mfma_f32_16x16x32_bf16 v[132:135], v[188:191], v[188:191], v[132:135]
    v_mfma_f32_16x16x32_bf16 v[128:131], v[140:143], v[192:195], v[128:131]
    v_mfma_f32_16x16x32_bf16 v[132:135], v[192:195], v[192:195], v[132:135]
    s_waitcnt lgkmcnt(8)
    s_waitcnt lgkmcnt(0)
    v_mfma_f32_16x16x32_bf16 v[32:35], a[96:99], v[96:99], v[32:35]
    ds_read_b64_tr_b16 v[112:113], v136 offset:28672
    v_mfma_f32_16x16x32_bf16 v[36:39], a[96:99], v[100:103], v[36:39]
    ds_read_b64_tr_b16 v[114:115], v136 offset:30720
    v_mfma_f32_16x16x32_bf16 v[40:43], a[96:99], v[104:107], v[40:43]
    ds_read_b64_tr_b16 v[116:117], v137 offset:28672
    v_mfma_f32_16x16x32_bf16 v[44:47], a[96:99], v[108:111], v[44:47]
    ds_read_b64_tr_b16 v[118:119], v137 offset:30720
    v_mfma_f32_16x16x32_bf16 v[48:51], a[100:103], v[96:99], v[48:51]
    ds_read_b64_tr_b16 v[120:121], v138 offset:28672
    v_mfma_f32_16x16x32_bf16 v[52:55], a[100:103], v[100:103], v[52:55]
    ds_read_b64_tr_b16 v[122:123], v138 offset:30720
    v_mfma_f32_16x16x32_bf16 v[56:59], a[100:103], v[104:107], v[56:59]
    ds_read_b64_tr_b16 v[124:125], v139 offset:28672
    v_mfma_f32_16x16x32_bf16 v[60:63], a[100:103], v[108:111], v[60:63]
    ds_read_b64_tr_b16 v[126:127], v139 offset:30720
    v_mfma_f32_16x16x32_bf16 v[64:67], a[104:107], v[96:99], v[64:67]
    ds_read_b64_tr_b16 v[180:181], v136 offset:49152
    v_mfma_f32_16x16x32_bf16 v[68:71], a[104:107], v[100:103], v[68:71]
    ds_read_b64_tr_b16 v[182:183], v136 offset:51200
    v_mfma_f32_16x16x32_bf16 v[72:75], a[104:107], v[104:107], v[72:75]
    ds_read_b64_tr_b16 v[184:185], v136 offset:53248
    v_mfma_f32_16x16x32_bf16 v[76:79], a[104:107], v[108:111], v[76:79]
    ds_read_b64_tr_b16 v[186:187], v136 offset:55296
    v_mfma_f32_16x16x32_bf16 v[80:83], a[108:111], v[96:99], v[80:83]
    ds_read_b64_tr_b16 v[188:189], v136 offset:57344
    v_mfma_f32_16x16x32_bf16 v[84:87], a[108:111], v[100:103], v[84:87]
    ds_read_b64_tr_b16 v[190:191], v136 offset:59392
    v_mfma_f32_16x16x32_bf16 v[88:91], a[108:111], v[104:107], v[88:91]
    ds_read_b64_tr_b16 v[192:193], v136 offset:61440
    v_mfma_f32_16x16x32_bf16 v[92:95], a[108:111], v[108:111], v[92:95]
    s_waitcnt lgkmcnt(14)
    ds_read_b64_tr_b16 v[194:195], v136 offset:63488
    v_mfma_f32_16x16x32_bf16 v[128:131], v[140:143], v[164:167], v[128:131]
    v_mfma_f32_16x16x32_bf16 v[132:135], v[164:167], v[164:167], v[132:135]
    v_mfma_f32_16x16x32_bf16 v[128:131], v[140:143], v[168:171], v[128:131]
    v_mfma_f32_16x16x32_bf16 v[132:135], v[168:171], v[168:171], v[132:135]
    v_mfma_f32_16x16x32_bf16 v[128:131], v[140:143], v[172:175], v[128:131]
    v_mfma_f32_16x16x32_bf16 v[132:135], v[172:175], v[172:175], v[132:135]
    v_mfma_f32_16x16x32_bf16 v[128:131], v[140:143], v[176:179], v[128:131]
    v_mfma_f32_16x16x32_bf16 v[132:135], v[176:179], v[176:179], v[132:135]
    s_waitcnt lgkmcnt(8)
    s_waitcnt lgkmcnt(0)
    v_mfma_f32_16x16x32_bf16 v[32:35], a[112:115], v[112:115], v[32:35]
    ds_read_b64_tr_b16 v[96:97], v136 offset:32768
    v_mfma_f32_16x16x32_bf16 v[36:39], a[112:115], v[116:119], v[36:39]
    ds_read_b64_tr_b16 v[98:99], v136 offset:34816
    v_mfma_f32_16x16x32_bf16 v[40:43], a[112:115], v[120:123], v[40:43]
    ds_read_b64_tr_b16 v[100:101], v137 offset:32768
    v_mfma_f32_16x16x32_bf16 v[44:47], a[112:115], v[124:127], v[44:47]
    ds_read_b64_tr_b16 v[102:103], v137 offset:34816
    v_mfma_f32_16x16x32_bf16 v[48:51], a[116:119], v[112:115], v[48:51]
    ds_read_b64_tr_b16 v[104:105], v138 offset:32768
    v_mfma_f32_16x16x32_bf16 v[52:55], a[116:119], v[116:119], v[52:55]
    ds_read_b64_tr_b16 v[106:107], v138 offset:34816
    v_mfma_f32_16x16x32_bf16 v[56:59], a[116:119], v[120:123], v[56:59]
    ds_read_b64_tr_b16 v[108:109], v139 offset:32768
    v_mfma_f32_16x16x32_bf16 v[60:63], a[116:119], v[124:127], v[60:63]
    ds_read_b64_tr_b16 v[110:111], v139 offset:34816
    v_mfma_f32_16x16x32_bf16 v[64:67], a[120:123], v[112:115], v[64:67]
    v_mfma_f32_16x16x32_bf16 v[68:71], a[120:123], v[116:119], v[68:71]
    v_mfma_f32_16x16x32_bf16 v[72:75], a[120:123], v[120:123], v[72:75]
    v_mfma_f32_16x16x32_bf16 v[76:79], a[120:123], v[124:127], v[76:79]
    v_mfma_f32_16x16x32_bf16 v[80:83], a[124:127], v[112:115], v[80:83]
    v_mfma_f32_16x16x32_bf16 v[84:87], a[124:127], v[116:119], v[84:87]
    v_mfma_f32_16x16x32_bf16 v[88:91], a[124:127], v[120:123], v[88:91]
    v_mfma_f32_16x16x32_bf16 v[92:95], a[124:127], v[124:127], v[92:95]
    v_mfma_f32_16x16x32_bf16 v[128:131], v[140:143], v[180:183], v[128:131]
    v_mfma_f32_16x16x32_bf16 v[132:135], v[180:183], v[180:183], v[132:135]
    v_mfma_f32_16x16x32_bf16 v[128:131], v[140:143], v[184:187], v[128:131]
    v_mfma_f32_16x16x32_bf16 v[132:135], v[184:187], v[184:187], v[132:135]
    v_mfma_f32_16x16x32_bf16 v[128:131], v[140:143], v[188:191], v[128:131]
    v_mfma_f32_16x16x32_bf16 v[132:135], v[188:191], v[188:191], v[132:135]
    v_mfma_f32_16x16x32_bf16 v[128:131], v[140:143], v[192:195], v[128:131]
    v_mfma_f32_16x16x32_bf16 v[132:135], v[192:195], v[192:195], v[132:135]
    s_waitcnt lgkmcnt(0)
    v_mfma_f32_16x16x32_bf16 v[32:35], a[128:131], v[96:99], v[32:35]
    ds_read_b64_tr_b16 v[112:113], v136 offset:36864
    v_mfma_f32_16x16x32_bf16 v[36:39], a[128:131], v[100:103], v[36:39]
    ds_read_b64_tr_b16 v[114:115], v136 offset:38912
    v_mfma_f32_16x16x32_bf16 v[40:43], a[128:131], v[104:107], v[40:43]
    ds_read_b64_tr_b16 v[116:117], v137 offset:36864
    v_mfma_f32_16x16x32_bf16 v[44:47], a[128:131], v[108:111], v[44:47]
    ds_read_b64_tr_b16 v[118:119], v137 offset:38912
    v_mfma_f32_16x16x32_bf16 v[48:51], a[132:135], v[96:99], v[48:51]
    ds_read_b64_tr_b16 v[120:121], v138 offset:36864
    v_mfma_f32_16x16x32_bf16 v[52:55], a[132:135], v[100:103], v[52:55]
    ds_read_b64_tr_b16 v[122:123], v138 offset:38912
    v_mfma_f32_16x16x32_bf16 v[56:59], a[132:135], v[104:107], v[56:59]
    ds_read_b64_tr_b16 v[124:125], v139 offset:36864
    v_mfma_f32_16x16x32_bf16 v[60:63], a[132:135], v[108:111], v[60:63]
    ds_read_b64_tr_b16 v[126:127], v139 offset:38912
    v_mfma_f32_16x16x32_bf16 v[64:67], a[136:139], v[96:99], v[64:67]
    v_mfma_f32_16x16x32_bf16 v[68:71], a[136:139], v[100:103], v[68:71]
    v_mfma_f32_16x16x32_bf16 v[72:75], a[136:139], v[104:107], v[72:75]
    v_mfma_f32_16x16x32_bf16 v[76:79], a[136:139], v[108:111], v[76:79]
    v_mfma_f32_16x16x32_bf16 v[80:83], a[140:143], v[96:99], v[80:83]
    v_mfma_f32_16x16x32_bf16 v[84:87], a[140:143], v[100:103], v[84:87]
    v_mfma_f32_16x16x32_bf16 v[88:91], a[140:143], v[104:107], v[88:91]
    v_mfma_f32_16x16x32_bf16 v[92:95], a[140:143], v[108:111], v[92:95]
    v_and_b32 v144, 3, v27
    v_cmp_eq_u32 vcc, 1, v144
    v_cmp_eq_u32 s[52:53], 2, v144
    v_cmp_eq_u32 s[54:55], 3, v144
    v_cndmask_b32 v145, v132, v133, vcc
    v_cndmask_b32 v145, v145, v134, s[52:53]
    v_cndmask_b32 v145, v145, v135, s[54:55]
    v_mul_f32 v146, 0x3b000000, v128
    v_mul_f32 v145, 0x3b000000, v145
    v_fma_f32 v145, -v146, v146, v145
    v_max_f32 v145, 0, v145
    v_add_f32 v145, 0x3727c5ac, v145
    v_rsq_f32 v148, v145
    v_lshrrev_b32 v147, 2, v27
    v_mul_f32 v149, v148, v146
    v_cmp_eq_u32 vcc, v147, v28
    s_lshl_b32 s50, s3, 7
    s_add_u32 s50, s50, 0x27e00
    v_lshlrev_b32 v147, 3, v27
    v_add_u32 v147, s50, v147
    s_and_saveexec_b64 s[52:53], vcc
    ds_write_b64 v147, v[148:149]
    s_mov_b64 exec, s[52:53]
    s_waitcnt lgkmcnt(1)
    v_mfma_f32_16x16x32_bf16 v[32:35], a[144:147], v[112:115], v[32:35]
    ds_read_b64_tr_b16 v[96:97], v136 offset:40960
    v_mfma_f32_16x16x32_bf16 v[36:39], a[144:147], v[116:119], v[36:39]
    ds_read_b64_tr_b16 v[98:99], v136 offset:43008
    v_mfma_f32_16x16x32_bf16 v[40:43], a[144:147], v[120:123], v[40:43]
    ds_read_b64_tr_b16 v[100:101], v137 offset:40960
    v_mfma_f32_16x16x32_bf16 v[44:47], a[144:147], v[124:127], v[44:47]
    ds_read_b64_tr_b16 v[102:103], v137 offset:43008
    v_mfma_f32_16x16x32_bf16 v[48:51], a[148:151], v[112:115], v[48:51]
    ds_read_b64_tr_b16 v[104:105], v138 offset:40960
    v_mfma_f32_16x16x32_bf16 v[52:55], a[148:151], v[116:119], v[52:55]
    ds_read_b64_tr_b16 v[106:107], v138 offset:43008
    v_mfma_f32_16x16x32_bf16 v[56:59], a[148:151], v[120:123], v[56:59]
    ds_read_b64_tr_b16 v[108:109], v139 offset:40960
    v_mfma_f32_16x16x32_bf16 v[60:63], a[148:151], v[124:127], v[60:63]
    ds_read_b64_tr_b16 v[110:111], v139 offset:43008
    v_mfma_f32_16x16x32_bf16 v[64:67], a[152:155], v[112:115], v[64:67]
    v_mfma_f32_16x16x32_bf16 v[68:71], a[152:155], v[116:119], v[68:71]
    v_mfma_f32_16x16x32_bf16 v[72:75], a[152:155], v[120:123], v[72:75]
    v_mfma_f32_16x16x32_bf16 v[76:79], a[152:155], v[124:127], v[76:79]
    v_mfma_f32_16x16x32_bf16 v[80:83], a[156:159], v[112:115], v[80:83]
    v_mfma_f32_16x16x32_bf16 v[84:87], a[156:159], v[116:119], v[84:87]
    v_mfma_f32_16x16x32_bf16 v[88:91], a[156:159], v[120:123], v[88:91]
    v_mfma_f32_16x16x32_bf16 v[92:95], a[156:159], v[124:127], v[92:95]
    s_waitcnt lgkmcnt(8)
    s_barrier
    v_lshlrev_b32 v147, 3, v27
    s_add_u32 s50, s3, 0
    s_and_b32 s50, s50, 3
    s_lshl_b32 s50, s50, 7
    s_add_u32 s50, s50, 0x27e00
    v_add_u32 v148, s50, v147
    ds_read_b64 v[150:151], v148
    s_add_u32 s50, s3, 1
    s_and_b32 s50, s50, 3
    s_lshl_b32 s50, s50, 7
    s_add_u32 s50, s50, 0x27e00
    v_add_u32 v148, s50, v147
    ds_read_b64 v[152:153], v148
    s_add_u32 s50, s3, 2
    s_and_b32 s50, s50, 3
    s_lshl_b32 s50, s50, 7
    s_add_u32 s50, s50, 0x27e00
    v_add_u32 v148, s50, v147
    ds_read_b64 v[154:155], v148
    s_add_u32 s50, s3, 3
    s_and_b32 s50, s50, 3
    s_lshl_b32 s50, s50, 7
    s_add_u32 s50, s50, 0x27e00
    v_add_u32 v148, s50, v147
    ds_read_b64 v[156:157], v148
    s_waitcnt lgkmcnt(4)
    v_mfma_f32_16x16x32_bf16 v[32:35], a[160:163], v[96:99], v[32:35]
    ds_read_b64_tr_b16 v[112:113], v136 offset:45056
    v_mfma_f32_16x16x32_bf16 v[36:39], a[160:163], v[100:103], v[36:39]
    ds_read_b64_tr_b16 v[114:115], v136 offset:47104
    v_mfma_f32_16x16x32_bf16 v[40:43], a[160:163], v[104:107], v[40:43]
    ds_read_b64_tr_b16 v[116:117], v137 offset:45056
    v_mfma_f32_16x16x32_bf16 v[44:47], a[160:163], v[108:111], v[44:47]
    ds_read_b64_tr_b16 v[118:119], v137 offset:47104
    v_mfma_f32_16x16x32_bf16 v[48:51], a[164:167], v[96:99], v[48:51]
    ds_read_b64_tr_b16 v[120:121], v138 offset:45056
    v_mfma_f32_16x16x32_bf16 v[52:55], a[164:167], v[100:103], v[52:55]
    ds_read_b64_tr_b16 v[122:123], v138 offset:47104
    v_mfma_f32_16x16x32_bf16 v[56:59], a[164:167], v[104:107], v[56:59]
    ds_read_b64_tr_b16 v[124:125], v139 offset:45056
    v_mfma_f32_16x16x32_bf16 v[60:63], a[164:167], v[108:111], v[60:63]
    ds_read_b64_tr_b16 v[126:127], v139 offset:47104
    v_mfma_f32_16x16x32_bf16 v[64:67], a[168:171], v[96:99], v[64:67]
    v_mfma_f32_16x16x32_bf16 v[68:71], a[168:171], v[100:103], v[68:71]
    v_mfma_f32_16x16x32_bf16 v[72:75], a[168:171], v[104:107], v[72:75]
    v_mfma_f32_16x16x32_bf16 v[76:79], a[168:171], v[108:111], v[76:79]
    v_mfma_f32_16x16x32_bf16 v[80:83], a[172:175], v[96:99], v[80:83]
    v_mfma_f32_16x16x32_bf16 v[84:87], a[172:175], v[100:103], v[84:87]
    v_mfma_f32_16x16x32_bf16 v[88:91], a[172:175], v[104:107], v[88:91]
    v_mfma_f32_16x16x32_bf16 v[92:95], a[172:175], v[108:111], v[92:95]
    s_waitcnt lgkmcnt(0)
    v_mfma_f32_16x16x32_bf16 v[32:35], a[176:179], v[112:115], v[32:35]
    ds_read_b64_tr_b16 v[96:97], v136 offset:49152
    v_mfma_f32_16x16x32_bf16 v[36:39], a[176:179], v[116:119], v[36:39]
    ds_read_b64_tr_b16 v[98:99], v136 offset:51200
    v_mfma_f32_16x16x32_bf16 v[40:43], a[176:179], v[120:123], v[40:43]
    ds_read_b64_tr_b16 v[100:101], v137 offset:49152
    v_mfma_f32_16x16x32_bf16 v[44:47], a[176:179], v[124:127], v[44:47]
    ds_read_b64_tr_b16 v[102:103], v137 offset:51200
    v_mfma_f32_16x16x32_bf16 v[48:51], a[180:183], v[112:115], v[48:51]
    ds_read_b64_tr_b16 v[104:105], v138 offset:49152
    v_mfma_f32_16x16x32_bf16 v[52:55], a[180:183], v[116:119], v[52:55]
    ds_read_b64_tr_b16 v[106:107], v138 offset:51200
    v_mfma_f32_16x16x32_bf16 v[56:59], a[180:183], v[120:123], v[56:59]
    ds_read_b64_tr_b16 v[108:109], v139 offset:49152
    v_mfma_f32_16x16x32_bf16 v[60:63], a[180:183], v[124:127], v[60:63]
    ds_read_b64_tr_b16 v[110:111], v139 offset:51200
    v_mfma_f32_16x16x32_bf16 v[64:67], a[184:187], v[112:115], v[64:67]
    v_mfma_f32_16x16x32_bf16 v[68:71], a[184:187], v[116:119], v[68:71]
    v_mfma_f32_16x16x32_bf16 v[72:75], a[184:187], v[120:123], v[72:75]
    v_mfma_f32_16x16x32_bf16 v[76:79], a[184:187], v[124:127], v[76:79]
    v_mfma_f32_16x16x32_bf16 v[80:83], a[188:191], v[112:115], v[80:83]
    v_mfma_f32_16x16x32_bf16 v[84:87], a[188:191], v[116:119], v[84:87]
    v_mfma_f32_16x16x32_bf16 v[88:91], a[188:191], v[120:123], v[88:91]
    v_mfma_f32_16x16x32_bf16 v[92:95], a[188:191], v[124:127], v[92:95]
    s_waitcnt lgkmcnt(0)
    v_mfma_f32_16x16x32_bf16 v[32:35], a[192:195], v[96:99], v[32:35]
    ds_read_b64_tr_b16 v[112:113], v136 offset:53248
    v_mfma_f32_16x16x32_bf16 v[36:39], a[192:195], v[100:103], v[36:39]
    ds_read_b64_tr_b16 v[114:115], v136 offset:55296
    s_lshr_b32 s67, s68, 1
    s_add_u32 s67, s67, 0
    s_and_b32 s67, s67, 7
    s_lshl_b32 s67, s67, 7
    s_add_u32 s67, s67, s57
    s_add_u32 m0, s56, 0x0
    s_nop 0
    buffer_load_dwordx4 v200, s[40:43], s67 offen lds
    v_mfma_f32_16x16x32_bf16 v[40:43], a[192:195], v[104:107], v[40:43]
    ds_read_b64_tr_b16 v[116:117], v137 offset:53248
    v_mfma_f32_16x16x32_bf16 v[44:47], a[192:195], v[108:111], v[44:47]
    ds_read_b64_tr_b16 v[118:119], v137 offset:55296
    v_mfma_f32_16x16x32_bf16 v[48:51], a[196:199], v[96:99], v[48:51]
    ds_read_b64_tr_b16 v[120:121], v138 offset:53248
    v_mfma_f32_16x16x32_bf16 v[52:55], a[196:199], v[100:103], v[52:55]
    ds_read_b64_tr_b16 v[122:123], v138 offset:55296
    s_add_u32 m0, s56, 0x400
    s_nop 0
    buffer_load_dwordx4 v201, s[40:43], s67 offen lds
    v_mfma_f32_16x16x32_bf16 v[56:59], a[196:199], v[104:107], v[56:59]
    ds_read_b64_tr_b16 v[124:125], v139 offset:53248
    v_mfma_f32_16x16x32_bf16 v[60:63], a[196:199], v[108:111], v[60:63]
    ds_read_b64_tr_b16 v[126:127], v139 offset:55296
    v_mfma_f32_16x16x32_bf16 v[64:67], a[200:203], v[96:99], v[64:67]
    v_mfma_f32_16x16x32_bf16 v[68:71], a[200:203], v[100:103], v[68:71]
    s_add_u32 m0, s56, 0x800
    s_nop 0
    buffer_load_dwordx4 v202, s[40:43], s67 offen lds
    v_mfma_f32_16x16x32_bf16 v[72:75], a[200:203], v[104:107], v[72:75]
    v_mfma_f32_16x16x32_bf16 v[76:79], a[200:203], v[108:111], v[76:79]
    v_mfma_f32_16x16x32_bf16 v[80:83], a[204:207], v[96:99], v[80:83]
    v_mfma_f32_16x16x32_bf16 v[84:87], a[204:207], v[100:103], v[84:87]
    s_add_u32 m0, s56, 0xc00
    s_nop 0
    buffer_load_dwordx4 v203, s[40:43], s67 offen lds
    v_mfma_f32_16x16x32_bf16 v[88:91], a[204:207], v[104:107], v[88:91]
    v_mfma_f32_16x16x32_bf16 v[92:95], a[204:207], v[108:111], v[92:95]
    s_add_u32 m0, s56, 0x1000
    s_nop 0
    buffer_load_dwordx4 v204, s[40:43], s67 offen lds
    s_add_u32 m0, s56, 0x1400
    s_nop 0
    buffer_load_dwordx4 v205, s[40:43], s67 offen lds
    s_waitcnt lgkmcnt(0)
    v_mfma_f32_16x16x32_bf16 v[32:35], a[208:211], v[112:115], v[32:35]
    ds_read_b64_tr_b16 v[96:97], v136 offset:57344
    v_mfma_f32_16x16x32_bf16 v[36:39], a[208:211], v[116:119], v[36:39]
    ds_read_b64_tr_b16 v[98:99], v136 offset:59392
    s_add_u32 m0, s56, 0x1800
    s_nop 0
    buffer_load_dwordx4 v206, s[40:43], s67 offen lds
    v_mfma_f32_16x16x32_bf16 v[40:43], a[208:211], v[120:123], v[40:43]
    ds_read_b64_tr_b16 v[100:101], v137 offset:57344
    v_mfma_f32_16x16x32_bf16 v[44:47], a[208:211], v[124:127], v[44:47]
    ds_read_b64_tr_b16 v[102:103], v137 offset:59392
    v_mfma_f32_16x16x32_bf16 v[48:51], a[212:215], v[112:115], v[48:51]
    ds_read_b64_tr_b16 v[104:105], v138 offset:57344
    v_mfma_f32_16x16x32_bf16 v[52:55], a[212:215], v[116:119], v[52:55]
    ds_read_b64_tr_b16 v[106:107], v138 offset:59392
    s_add_u32 m0, s56, 0x1c00
    s_nop 0
    buffer_load_dwordx4 v207, s[40:43], s67 offen lds
    v_mfma_f32_16x16x32_bf16 v[56:59], a[212:215], v[120:123], v[56:59]
    ds_read_b64_tr_b16 v[108:109], v139 offset:57344
    v_mfma_f32_16x16x32_bf16 v[60:63], a[212:215], v[124:127], v[60:63]
    ds_read_b64_tr_b16 v[110:111], v139 offset:59392
    v_mfma_f32_16x16x32_bf16 v[64:67], a[216:219], v[112:115], v[64:67]
    v_mfma_f32_16x16x32_bf16 v[68:71], a[216:219], v[116:119], v[68:71]
    s_lshr_b32 s67, s68, 1
    s_add_u32 s67, s67, 1
    s_and_b32 s67, s67, 7
    s_lshl_b32 s67, s67, 7
    s_add_u32 s67, s67, s57
    s_add_u32 m0, s56, 0x2000
    s_nop 0
    buffer_load_dwordx4 v200, s[40:43], s67 offen lds
    v_mfma_f32_16x16x32_bf16 v[72:75], a[216:219], v[120:123], v[72:75]
    v_mfma_f32_16x16x32_bf16 v[76:79], a[216:219], v[124:127], v[76:79]
    v_mfma_f32_16x16x32_bf16 v[80:83], a[220:223], v[112:115], v[80:83]
    v_mfma_f32_16x16x32_bf16 v[84:87], a[220:223], v[116:119], v[84:87]
    s_add_u32 m0, s56, 0x2400
    s_nop 0
    buffer_load_dwordx4 v201, s[40:43], s67 offen lds
    v_mfma_f32_16x16x32_bf16 v[88:91], a[220:223], v[120:123], v[88:91]
    v_mfma_f32_16x16x32_bf16 v[92:95], a[220:223], v[124:127], v[92:95]
    s_add_u32 m0, s56, 0x2800
    s_nop 0
    buffer_load_dwordx4 v202, s[40:43], s67 offen lds
    s_add_u32 m0, s56, 0x2c00
    s_nop 0
    buffer_load_dwordx4 v203, s[40:43], s67 offen lds
    s_waitcnt lgkmcnt(0)
    v_mfma_f32_16x16x32_bf16 v[32:35], a[224:227], v[96:99], v[32:35]
    ds_read_b64_tr_b16 v[112:113], v136 offset:61440
    v_mfma_f32_16x16x32_bf16 v[36:39], a[224:227], v[100:103], v[36:39]
    ds_read_b64_tr_b16 v[114:115], v136 offset:63488
    s_add_u32 m0, s56, 0x3000
    s_nop 0
    buffer_load_dwordx4 v204, s[40:43], s67 offen lds
    v_mfma_f32_16x16x32_bf16 v[40:43], a[224:227], v[104:107], v[40:43]
    ds_read_b64_tr_b16 v[116:117], v137 offset:61440
    v_mfma_f32_16x16x32_bf16 v[44:47], a[224:227], v[108:111], v[44:47]
    ds_read_b64_tr_b16 v[118:119], v137 offset:63488
    v_mfma_f32_16x16x32_bf16 v[48:51], a[228:231], v[96:99], v[48:51]
    ds_read_b64_tr_b16 v[120:121], v138 offset:61440
    v_mfma_f32_16x16x32_bf16 v[52:55], a[228:231], v[100:103], v[52:55]
    ds_read_b64_tr_b16 v[122:123], v138 offset:63488
    s_add_u32 m0, s56, 0x3400
    s_nop 0
    buffer_load_dwordx4 v205, s[40:43], s67 offen lds
    v_mfma_f32_16x16x32_bf16 v[56:59], a[228:231], v[104:107], v[56:59]
    ds_read_b64_tr_b16 v[124:125], v139 offset:61440
    v_mfma_f32_16x16x32_bf16 v[60:63], a[228:231], v[108:111], v[60:63]
    ds_read_b64_tr_b16 v[126:127], v139 offset:63488
    v_mfma_f32_16x16x32_bf16 v[64:67], a[232:235], v[96:99], v[64:67]
    v_mfma_f32_16x16x32_bf16 v[68:71], a[232:235], v[100:103], v[68:71]
    s_add_u32 m0, s56, 0x3800
    s_nop 0
    buffer_load_dwordx4 v206, s[40:43], s67 offen lds
    v_mfma_f32_16x16x32_bf16 v[72:75], a[232:235], v[104:107], v[72:75]
    v_mfma_f32_16x16x32_bf16 v[76:79], a[232:235], v[108:111], v[76:79]
    v_mfma_f32_16x16x32_bf16 v[80:83], a[236:239], v[96:99], v[80:83]
    v_mfma_f32_16x16x32_bf16 v[84:87], a[236:239], v[100:103], v[84:87]
    s_add_u32 m0, s56, 0x3c00
    s_nop 0
    buffer_load_dwordx4 v207, s[40:43], s67 offen lds
    v_mfma_f32_16x16x32_bf16 v[88:91], a[236:239], v[104:107], v[88:91]
    v_mfma_f32_16x16x32_bf16 v[92:95], a[236:239], v[108:111], v[92:95]
    s_lshr_b32 s67, s68, 1
    s_add_u32 s67, s67, 2
    s_and_b32 s67, s67, 7
    s_lshl_b32 s67, s67, 7
    s_add_u32 s67, s67, s57
    s_add_u32 m0, s56, 0x4000
    s_nop 0
    buffer_load_dwordx4 v200, s[40:43], s67 offen lds
    s_add_u32 m0, s56, 0x4400
    s_nop 0
    buffer_load_dwordx4 v201, s[40:43], s67 offen lds
    s_waitcnt lgkmcnt(0)
    v_mfma_f32_16x16x32_bf16 v[32:35], a[240:243], v[112:115], v[32:35]
    v_mfma_f32_16x16x32_bf16 v[36:39], a[240:243], v[116:119], v[36:39]
    s_add_u32 m0, s56, 0x4800
    s_nop 0
    buffer_load_dwordx4 v202, s[40:43], s67 offen lds
    v_mfma_f32_16x16x32_bf16 v[40:43], a[240:243], v[120:123], v[40:43]
    v_mfma_f32_16x16x32_bf16 v[44:47], a[240:243], v[124:127], v[44:47]
    v_mfma_f32_16x16x32_bf16 v[48:51], a[244:247], v[112:115], v[48:51]
    v_mfma_f32_16x16x32_bf16 v[52:55], a[244:247], v[116:119], v[52:55]
    s_add_u32 m0, s56, 0x4c00
    s_nop 0
    buffer_load_dwordx4 v203, s[40:43], s67 offen lds
    v_mfma_f32_16x16x32_bf16 v[56:59], a[244:247], v[120:123], v[56:59]
    v_mfma_f32_16x16x32_bf16 v[60:63], a[244:247], v[124:127], v[60:63]
    v_mfma_f32_16x16x32_bf16 v[64:67], a[248:251], v[112:115], v[64:67]
    v_mfma_f32_16x16x32_bf16 v[68:71], a[248:251], v[116:119], v[68:71]
    s_add_u32 m0, s56, 0x5000
    s_nop 0
    buffer_load_dwordx4 v204, s[40:43], s67 offen lds
    v_mfma_f32_16x16x32_bf16 v[72:75], a[248:251], v[120:123], v[72:75]
    v_mfma_f32_16x16x32_bf16 v[76:79], a[248:251], v[124:127], v[76:79]
    v_mfma_f32_16x16x32_bf16 v[80:83], a[252:255], v[112:115], v[80:83]
    v_mfma_f32_16x16x32_bf16 v[84:87], a[252:255], v[116:119], v[84:87]
    s_add_u32 m0, s56, 0x5400
    s_nop 0
    buffer_load_dwordx4 v205, s[40:43], s67 offen lds
    v_mfma_f32_16x16x32_bf16 v[88:91], a[252:255], v[120:123], v[88:91]
    v_mfma_f32_16x16x32_bf16 v[92:95], a[252:255], v[124:127], v[92:95]
    s_add_u32 m0, s56, 0x5800
    s_nop 0
    buffer_load_dwordx4 v206, s[40:43], s67 offen lds
    s_add_u32 m0, s56, 0x5c00
    s_nop 0
    buffer_load_dwordx4 v207, s[40:43], s67 offen lds
    s_lshr_b32 s50, s49, 1
    s_lshl_b32 s50, s50, 2
    s_add_u32 s50, s50, s3
    s_sub_u32 s50, s50, s64
    s_and_b32 s50, s50, 15
    s_lshl_b32 s50, s50, 12
    s_and_b32 s51, s49, 1
    s_lshl_b32 s51, s51, 1
    s_add_u32 s51, s51, 0
    s_xor_b32 s51, s51, s3
    s_lshl_b32 s51, s51, 5
    v_xor_b32 v144, s51, v136
    v_add_u32 v144, s50, v144
    s_and_b32 s51, s49, 1
    s_lshl_b32 s51, s51, 1
    s_add_u32 s51, s51, 1
    s_xor_b32 s51, s51, s3
    s_lshl_b32 s51, s51, 5
    v_xor_b32 v145, s51, v136
    v_add_u32 v145, s50, v145
    ds_read_b64_tr_b16 v[18:19], v144 offset:0
    ds_read_b64_tr_b16 v[20:21], v144 offset:2048
    ds_read_b64_tr_b16 v[22:23], v145 offset:0
    ds_read_b64_tr_b16 v[24:25], v145 offset:2048
    s_mov_b32 s60, 0xc0135761
    s_mov_b32 s61, 0xc0135761
    s_mov_b32 s62, 0xbdd2d3e8
    s_mov_b32 s63, 0xbdd2d3e8
    v_mov_b32 v162, s60
    v_mov_b32 v163, s60
    v_mov_b32 v164, 1.0
    v_mov_b32 v165, 1.0
    v_mov_b32 v170, s60
    v_mov_b32 v171, s60
    v_mov_b32 v172, 1.0
    v_mov_b32 v173, 1.0
    v_pk_mul_f32 v[160:161], v[2:3], v[150:151] op_sel:[0,1] op_sel_hi:[1,1]
    v_pk_mul_f32 v[168:169], v[4:5], v[150:151] op_sel:[0,1] op_sel_hi:[1,1]
    v_pk_fma_f32 v[32:33], v[32:33], v[150:151], v[160:161] op_sel_hi:[1,0,1] neg_lo:[0,0,1] neg_hi:[0,0,1]
    v_pk_fma_f32 v[34:35], v[34:35], v[150:151], v[168:169] op_sel_hi:[1,0,1] neg_lo:[0,0,1] neg_hi:[0,0,1]
    v_pk_mul_f32 v[160:161], v[32:33], v[32:33]
    v_pk_mul_f32 v[168:169], v[34:35], v[34:35]
    v_pk_fma_f32 v[160:161], v[160:161], s[62:63], v[162:163]
    v_pk_fma_f32 v[168:169], v[168:169], s[62:63], v[170:171]
    v_pk_mul_f32 v[160:161], v[160:161], v[32:33]
    v_pk_mul_f32 v[168:169], v[168:169], v[34:35]
    v_exp_f32 v160, v160
    v_exp_f32 v161, v161
    v_exp_f32 v168, v168
    v_exp_f32 v169, v169
    s_nop 0
    v_pk_add_f32 v[160:161], v[160:161], v[164:165]
    v_pk_add_f32 v[168:169], v[168:169], v[172:173]
    v_rcp_f32 v160, v160
    v_rcp_f32 v161, v161
    v_rcp_f32 v168, v168
    v_rcp_f32 v169, v169
    s_nop 0
    v_pk_mul_f32 v[32:33], v[32:33], v[160:161]
    v_pk_mul_f32 v[34:35], v[34:35], v[168:169]
    v_pk_add_f32 v[176:177], v[32:33], v[34:35]
    v_pk_mul_f32 v[178:179], v[32:33], v[32:33]
    v_pk_fma_f32 v[178:179], v[34:35], v[34:35], v[178:179]
    v_pk_mul_f32 v[160:161], v[6:7], v[150:151] op_sel:[0,1] op_sel_hi:[1,1]
    v_pk_mul_f32 v[168:169], v[8:9], v[150:151] op_sel:[0,1] op_sel_hi:[1,1]
    v_pk_fma_f32 v[48:49], v[48:49], v[150:151], v[160:161] op_sel_hi:[1,0,1] neg_lo:[0,0,1] neg_hi:[0,0,1]
    v_pk_fma_f32 v[50:51], v[50:51], v[150:151], v[168:169] op_sel_hi:[1,0,1] neg_lo:[0,0,1] neg_hi:[0,0,1]
    v_pk_mul_f32 v[160:161], v[48:49], v[48:49]
    v_pk_mul_f32 v[168:169], v[50:51], v[50:51]
    v_pk_fma_f32 v[160:161], v[160:161], s[62:63], v[162:163]
    v_pk_fma_f32 v[168:169], v[168:169], s[62:63], v[170:171]
    v_pk_mul_f32 v[160:161], v[160:161], v[48:49]
    v_pk_mul_f32 v[168:169], v[168:169], v[50:51]
    v_exp_f32 v160, v160
    v_exp_f32 v161, v161
    v_exp_f32 v168, v168
    v_exp_f32 v169, v169
    s_nop 0
    v_pk_add_f32 v[160:161], v[160:161], v[164:165]
    v_pk_add_f32 v[168:169], v[168:169], v[172:173]
    v_rcp_f32 v160, v160
    v_rcp_f32 v161, v161
    v_rcp_f32 v168, v168
    v_rcp_f32 v169, v169
    s_nop 0
    v_pk_mul_f32 v[48:49], v[48:49], v[160:161]
    v_pk_mul_f32 v[50:51], v[50:51], v[168:169]
    v_pk_add_f32 v[176:177], v[176:177], v[48:49]
    v_pk_add_f32 v[176:177], v[176:177], v[50:51]
    v_pk_fma_f32 v[178:179], v[48:49], v[48:49], v[178:179]
    v_pk_fma_f32 v[178:179], v[50:51], v[50:51], v[178:179]
    v_pk_mul_f32 v[160:161], v[2:3], v[152:153] op_sel:[0,1] op_sel_hi:[1,1]
    v_pk_mul_f32 v[168:169], v[4:5], v[152:153] op_sel:[0,1] op_sel_hi:[1,1]
    v_pk_fma_f32 v[36:37], v[36:37], v[152:153], v[160:161] op_sel_hi:[1,0,1] neg_lo:[0,0,1] neg_hi:[0,0,1]
    v_pk_fma_f32 v[38:39], v[38:39], v[152:153], v[168:169] op_sel_hi:[1,0,1] neg_lo:[0,0,1] neg_hi:[0,0,1]
    v_pk_mul_f32 v[160:161], v[36:37], v[36:37]
    v_pk_mul_f32 v[168:169], v[38:39], v[38:39]
    v_pk_fma_f32 v[160:161], v[160:161], s[62:63], v[162:163]
    v_pk_fma_f32 v[168:169], v[168:169], s[62:63], v[170:171]
    v_pk_mul_f32 v[160:161], v[160:161], v[36:37]
    v_pk_mul_f32 v[168:169], v[168:169], v[38:39]
    v_exp_f32 v160, v160
    v_exp_f32 v161, v161
    v_exp_f32 v168, v168
    v_exp_f32 v169, v169
    s_nop 0
    v_pk_add_f32 v[160:161], v[160:161], v[164:165]
    v_pk_add_f32 v[168:169], v[168:169], v[172:173]
    v_rcp_f32 v160, v160
    v_rcp_f32 v161, v161
    v_rcp_f32 v168, v168
    v_rcp_f32 v169, v169
    s_nop 0
    v_pk_mul_f32 v[36:37], v[36:37], v[160:161]
    v_pk_mul_f32 v[38:39], v[38:39], v[168:169]
    v_pk_add_f32 v[180:181], v[36:37], v[38:39]
    v_pk_mul_f32 v[182:183], v[36:37], v[36:37]
    v_pk_fma_f32 v[182:183], v[38:39], v[38:39], v[182:183]
    v_pk_mul_f32 v[160:161], v[6:7], v[152:153] op_sel:[0,1] op_sel_hi:[1,1]
    v_pk_mul_f32 v[168:169], v[8:9], v[152:153] op_sel:[0,1] op_sel_hi:[1,1]
    v_pk_fma_f32 v[52:53], v[52:53], v[152:153], v[160:161] op_sel_hi:[1,0,1] neg_lo:[0,0,1] neg_hi:[0,0,1]
    v_pk_fma_f32 v[54:55], v[54:55], v[152:153], v[168:169] op_sel_hi:[1,0,1] neg_lo:[0,0,1] neg_hi:[0,0,1]
    v_pk_mul_f32 v[160:161], v[52:53], v[52:53]
    v_pk_mul_f32 v[168:169], v[54:55], v[54:55]
    v_pk_fma_f32 v[160:161], v[160:161], s[62:63], v[162:163]
    v_pk_fma_f32 v[168:169], v[168:169], s[62:63], v[170:171]
    v_pk_mul_f32 v[160:161], v[160:161], v[52:53]
    v_pk_mul_f32 v[168:169], v[168:169], v[54:55]
    v_exp_f32 v160, v160
    v_exp_f32 v161, v161
    v_exp_f32 v168, v168
    v_exp_f32 v169, v169
    s_nop 0
    v_pk_add_f32 v[160:161], v[160:161], v[164:165]
    v_pk_add_f32 v[168:169], v[168:169], v[172:173]
    v_rcp_f32 v160, v160
    v_rcp_f32 v161, v161
    v_rcp_f32 v168, v168
    v_rcp_f32 v169, v169
    s_nop 0
    v_pk_mul_f32 v[52:53], v[52:53], v[160:161]
    v_pk_mul_f32 v[54:55], v[54:55], v[168:169]
    v_pk_add_f32 v[180:181], v[180:181], v[52:53]
    v_pk_add_f32 v[180:181], v[180:181], v[54:55]
    v_pk_fma_f32 v[182:183], v[52:53], v[52:53], v[182:183]
    v_pk_fma_f32 v[182:183], v[54:55], v[54:55], v[182:183]
    v_pk_mul_f32 v[160:161], v[2:3], v[154:155] op_sel:[0,1] op_sel_hi:[1,1]
    v_pk_mul_f32 v[168:169], v[4:5], v[154:155] op_sel:[0,1] op_sel_hi:[1,1]
    v_pk_fma_f32 v[40:41], v[40:41], v[154:155], v[160:161] op_sel_hi:[1,0,1] neg_lo:[0,0,1] neg_hi:[0,0,1]
    v_pk_fma_f32 v[42:43], v[42:43], v[154:155], v[168:169] op_sel_hi:[1,0,1] neg_lo:[0,0,1] neg_hi:[0,0,1]
    v_pk_mul_f32 v[160:161], v[40:41], v[40:41]
    v_pk_mul_f32 v[168:169], v[42:43], v[42:43]
    v_pk_fma_f32 v[160:161], v[160:161], s[62:63], v[162:163]
    v_pk_fma_f32 v[168:169], v[168:169], s[62:63], v[170:171]
    v_pk_mul_f32 v[160:161], v[160:161], v[40:41]
    v_pk_mul_f32 v[168:169], v[168:169], v[42:43]
    v_exp_f32 v160, v160
    v_exp_f32 v161, v161
    v_exp_f32 v168, v168
    v_exp_f32 v169, v169
    s_nop 0
    v_pk_add_f32 v[160:161], v[160:161], v[164:165]
    v_pk_add_f32 v[168:169], v[168:169], v[172:173]
    v_rcp_f32 v160, v160
    v_rcp_f32 v161, v161
    v_rcp_f32 v168, v168
    v_rcp_f32 v169, v169
    s_nop 0
    v_pk_mul_f32 v[40:41], v[40:41], v[160:161]
    v_pk_mul_f32 v[42:43], v[42:43], v[168:169]
    v_pk_add_f32 v[184:185], v[40:41], v[42:43]
    v_pk_mul_f32 v[186:187], v[40:41], v[40:41]
    v_pk_fma_f32 v[186:187], v[42:43], v[42:43], v[186:187]
    v_pk_mul_f32 v[160:161], v[6:7], v[154:155] op_sel:[0,1] op_sel_hi:[1,1]
    v_pk_mul_f32 v[168:169], v[8:9], v[154:155] op_sel:[0,1] op_sel_hi:[1,1]
    v_pk_fma_f32 v[56:57], v[56:57], v[154:155], v[160:161] op_sel_hi:[1,0,1] neg_lo:[0,0,1] neg_hi:[0,0,1]
    v_pk_fma_f32 v[58:59], v[58:59], v[154:155], v[168:169] op_sel_hi:[1,0,1] neg_lo:[0,0,1] neg_hi:[0,0,1]
    v_pk_mul_f32 v[160:161], v[56:57], v[56:57]
    v_pk_mul_f32 v[168:169], v[58:59], v[58:59]
    v_pk_fma_f32 v[160:161], v[160:161], s[62:63], v[162:163]
    v_pk_fma_f32 v[168:169], v[168:169], s[62:63], v[170:171]
    v_pk_mul_f32 v[160:161], v[160:161], v[56:57]
    v_pk_mul_f32 v[168:169], v[168:169], v[58:59]
    v_exp_f32 v160, v160
    v_exp_f32 v161, v161
    v_exp_f32 v168, v168
    v_exp_f32 v169, v169
    s_nop 0
    v_pk_add_f32 v[160:161], v[160:161], v[164:165]
    v_pk_add_f32 v[168:169], v[168:169], v[172:173]
    v_rcp_f32 v160, v160
    v_rcp_f32 v161, v161
    v_rcp_f32 v168, v168
    v_rcp_f32 v169, v169
    s_nop 0
    v_pk_mul_f32 v[56:57], v[56:57], v[160:161]
    v_pk_mul_f32 v[58:59], v[58:59], v[168:169]
    v_pk_add_f32 v[184:185], v[184:185], v[56:57]
    v_pk_add_f32 v[184:185], v[184:185], v[58:59]
    v_pk_fma_f32 v[186:187], v[56:57], v[56:57], v[186:187]
    v_pk_fma_f32 v[186:187], v[58:59], v[58:59], v[186:187]
    v_pk_mul_f32 v[160:161], v[2:3], v[156:157] op_sel:[0,1] op_sel_hi:[1,1]
    v_pk_mul_f32 v[168:169], v[4:5], v[156:157] op_sel:[0,1] op_sel_hi:[1,1]
    v_pk_fma_f32 v[44:45], v[44:45], v[156:157], v[160:161] op_sel_hi:[1,0,1] neg_lo:[0,0,1] neg_hi:[0,0,1]
    v_pk_fma_f32 v[46:47], v[46:47], v[156:157], v[168:169] op_sel_hi:[1,0,1] neg_lo:[0,0,1] neg_hi:[0,0,1]
    v_pk_mul_f32 v[160:161], v[44:45], v[44:45]
    v_pk_mul_f32 v[168:169], v[46:47], v[46:47]
    v_pk_fma_f32 v[160:161], v[160:161], s[62:63], v[162:163]
    v_pk_fma_f32 v[168:169], v[168:169], s[62:63], v[170:171]
    v_pk_mul_f32 v[160:161], v[160:161], v[44:45]
    v_pk_mul_f32 v[168:169], v[168:169], v[46:47]
    v_exp_f32 v160, v160
    v_exp_f32 v161, v161
    v_exp_f32 v168, v168
    v_exp_f32 v169, v169
    s_nop 0
    v_pk_add_f32 v[160:161], v[160:161], v[164:165]
    v_pk_add_f32 v[168:169], v[168:169], v[172:173]
    v_rcp_f32 v160, v160
    v_rcp_f32 v161, v161
    v_rcp_f32 v168, v168
    v_rcp_f32 v169, v169
    s_nop 0
    v_pk_mul_f32 v[44:45], v[44:45], v[160:161]
    v_pk_mul_f32 v[46:47], v[46:47], v[168:169]
    v_pk_add_f32 v[188:189], v[44:45], v[46:47]
    v_pk_mul_f32 v[190:191], v[44:45], v[44:45]
    v_pk_fma_f32 v[190:191], v[46:47], v[46:47], v[190:191]
    v_pk_mul_f32 v[160:161], v[6:7], v[156:157] op_sel:[0,1] op_sel_hi:[1,1]
    v_pk_mul_f32 v[168:169], v[8:9], v[156:157] op_sel:[0,1] op_sel_hi:[1,1]
    v_pk_fma_f32 v[60:61], v[60:61], v[156:157], v[160:161] op_sel_hi:[1,0,1] neg_lo:[0,0,1] neg_hi:[0,0,1]
    v_pk_fma_f32 v[62:63], v[62:63], v[156:157], v[168:169] op_sel_hi:[1,0,1] neg_lo:[0,0,1] neg_hi:[0,0,1]
    v_pk_mul_f32 v[160:161], v[60:61], v[60:61]
    v_pk_mul_f32 v[168:169], v[62:63], v[62:63]
    v_pk_fma_f32 v[160:161], v[160:161], s[62:63], v[162:163]
    v_pk_fma_f32 v[168:169], v[168:169], s[62:63], v[170:171]
    v_pk_mul_f32 v[160:161], v[160:161], v[60:61]
    v_pk_mul_f32 v[168:169], v[168:169], v[62:63]
    v_exp_f32 v160, v160
    v_exp_f32 v161, v161
    v_exp_f32 v168, v168
    v_exp_f32 v169, v169
    s_nop 0
    v_pk_add_f32 v[160:161], v[160:161], v[164:165]
    v_pk_add_f32 v[168:169], v[168:169], v[172:173]
    v_rcp_f32 v160, v160
    v_rcp_f32 v161, v161
    v_rcp_f32 v168, v168
    v_rcp_f32 v169, v169
    s_nop 0
    v_pk_mul_f32 v[60:61], v[60:61], v[160:161]
    v_pk_mul_f32 v[62:63], v[62:63], v[168:169]
    v_pk_add_f32 v[188:189], v[188:189], v[60:61]
    v_pk_add_f32 v[188:189], v[188:189], v[62:63]
    v_pk_fma_f32 v[190:191], v[60:61], v[60:61], v[190:191]
    v_pk_fma_f32 v[190:191], v[62:63], v[62:63], v[190:191]
    s_waitcnt lgkmcnt(0)
    s_barrier
    s_lshl_b32 s51, s3, 11
    s_add_u32 s51, s51, 0x9000
    v_lshlrev_b32 v160, 9, v28
    v_lshl_add_u32 v160, v27, 3, v160
    v_add_u32 v160, s51, v160
    v_add_f32 v176, v176, v177
    v_add_f32 v177, v178, v179
    s_add_u32 s50, s3, 0
    s_and_b32 s50, s50, 3
    s_lshl_b32 s50, s50, 7
    v_add_u32 v161, s50, v160
    ds_write_b64 v161, v[176:177]
    v_add_f32 v180, v180, v181
    v_add_f32 v181, v182, v183
    s_add_u32 s50, s3, 1
    s_and_b32 s50, s50, 3
    s_lshl_b32 s50, s50, 7
    v_add_u32 v161, s50, v160
    ds_write_b64 v161, v[180:181]
    v_add_f32 v184, v184, v185
    v_add_f32 v185, v186, v187
    s_add_u32 s50, s3, 2
    s_and_b32 s50, s50, 3
    s_lshl_b32 s50, s50, 7
    v_add_u32 v161, s50, v160
    ds_write_b64 v161, v[184:185]
    v_add_f32 v188, v188, v189
    v_add_f32 v189, v190, v191
    s_add_u32 s50, s3, 3
    s_and_b32 s50, s50, 3
    s_lshl_b32 s50, s50, 7
    v_add_u32 v161, s50, v160
    ds_write_b64 v161, v[188:189]
    s_waitcnt lgkmcnt(0)
    s_barrier
    s_lshl_b32 s50, s3, 7
    s_add_u32 s50, s50, 0x9000
    v_lshlrev_b32 v160, 9, v28
    v_lshl_add_u32 v160, v27, 3, v160
    v_add_u32 v160, s50, v160
    ds_read_b64 v[176:177], v160 offset:0
    ds_read_b64 v[178:179], v160 offset:2048
    ds_read_b64 v[180:181], v160 offset:4096
    ds_read_b64 v[182:183], v160 offset:6144
    s_waitcnt lgkmcnt(0)
    v_pk_add_f32 v[176:177], v[176:177], v[178:179]
    v_pk_add_f32 v[180:181], v[180:181], v[182:183]
    v_pk_add_f32 v[176:177], v[176:177], v[180:181]
    v_mov_b32 v178, v176
    v_mov_b32 v179, v177
    s_nop 1
    v_permlane16_swap_b32 v176, v178
    v_permlane16_swap_b32 v177, v179
    s_nop 0
    v_pk_add_f32 v[176:177], v[176:177], v[178:179]
    v_mov_b32 v178, v176
    v_mov_b32 v179, v177
    s_nop 1
    v_permlane32_swap_b32 v176, v178
    v_permlane32_swap_b32 v177, v179
    s_nop 0
    v_pk_add_f32 v[176:177], v[176:177], v[178:179]
    s_lshl_b32 s50, s48, 3
    s_add_u32 s50, s50, s49
    s_lshl_b32 s50, s50, 9
    s_lshl_b32 s51, s3, 7
    s_add_u32 s50, s50, s51
    s_add_u32 s50, s50, 0x1520000
    v_lshlrev_b32 v160, 3, v27
    s_mov_b64 s[52:53], exec
    s_mov_b64 exec, 0xffff
    buffer_store_dwordx2 v[176:177], v160, s[32:35], s50 offen offset:0 sc1
    s_mov_b64 exec, s[52:53]
    s_waitcnt vmcnt(17)
    ds_read_b64 a[0:1], v208 offset:0
    ds_read_b64 a[2:3], v209 offset:0
    ds_read_b64 a[4:5], v208 offset:2048
    ds_read_b64 a[6:7], v209 offset:2048
    ds_read_b64 a[8:9], v208 offset:4096
    ds_read_b64 a[10:11], v209 offset:4096
    ds_read_b64 a[12:13], v208 offset:6144
    ds_read_b64 a[14:15], v209 offset:6144
    ds_read_b64 a[16:17], v210 offset:0
    ds_read_b64 a[18:19], v211 offset:0
    ds_read_b64 a[20:21], v210 offset:2048
    ds_read_b64 a[22:23], v211 offset:2048
    ds_read_b64 a[24:25], v210 offset:4096
    ds_read_b64 a[26:27], v211 offset:4096
    ds_read_b64 a[28:29], v210 offset:6144
    s_waitcnt lgkmcnt(14)
    ds_read_b64 a[30:31], v211 offset:6144
    s_waitcnt vmcnt(9)
    s_waitcnt lgkmcnt(14)
    ds_read_b64 a[32:33], v208 offset:8192
    s_waitcnt lgkmcnt(14)
    ds_read_b64 a[34:35], v209 offset:8192
    s_waitcnt lgkmcnt(14)
    ds_read_b64 a[36:37], v208 offset:10240
    s_waitcnt lgkmcnt(14)
    ds_read_b64 a[38:39], v209 offset:10240
    s_waitcnt lgkmcnt(14)
    ds_read_b64 a[40:41], v208 offset:12288
    s_waitcnt lgkmcnt(14)
    ds_read_b64 a[42:43], v209 offset:12288
    s_waitcnt lgkmcnt(14)
    ds_read_b64 a[44:45], v208 offset:14336
    s_waitcnt lgkmcnt(14)
    ds_read_b64 a[46:47], v209 offset:14336
    s_waitcnt lgkmcnt(14)
    ds_read_b64 a[48:49], v210 offset:8192
    s_waitcnt lgkmcnt(14)
    ds_read_b64 a[50:51], v211 offset:8192
    s_waitcnt lgkmcnt(14)
    ds_read_b64 a[52:53], v210 offset:10240
    s_waitcnt lgkmcnt(14)
    ds_read_b64 a[54:55], v211 offset:10240
    s_waitcnt lgkmcnt(14)
    ds_read_b64 a[56:57], v210 offset:12288
    s_waitcnt lgkmcnt(14)
    ds_read_b64 a[58:59], v211 offset:12288
    s_waitcnt lgkmcnt(14)
    ds_read_b64 a[60:61], v210 offset:14336
    s_waitcnt lgkmcnt(14)
    ds_read_b64 a[62:63], v211 offset:14336
    s_waitcnt vmcnt(1)
    s_waitcnt lgkmcnt(14)
    ds_read_b64 a[64:65], v208 offset:16384
    s_waitcnt lgkmcnt(14)
    ds_read_b64 a[66:67], v209 offset:16384
    s_waitcnt lgkmcnt(14)
    ds_read_b64 a[68:69], v208 offset:18432
    s_waitcnt lgkmcnt(14)
    ds_read_b64 a[70:71], v209 offset:18432
    s_waitcnt lgkmcnt(14)
    ds_read_b64 a[72:73], v208 offset:20480
    s_waitcnt lgkmcnt(14)
    ds_read_b64 a[74:75], v209 offset:20480
    s_waitcnt lgkmcnt(14)
    ds_read_b64 a[76:77], v208 offset:22528
    s_waitcnt lgkmcnt(14)
    ds_read_b64 a[78:79], v209 offset:22528
    s_waitcnt lgkmcnt(14)
    ds_read_b64 a[80:81], v210 offset:16384
    s_waitcnt lgkmcnt(14)
    ds_read_b64 a[82:83], v211 offset:16384
    s_waitcnt lgkmcnt(14)
    ds_read_b64 a[84:85], v210 offset:18432
    s_waitcnt lgkmcnt(14)
    ds_read_b64 a[86:87], v211 offset:18432
    s_waitcnt lgkmcnt(14)
    ds_read_b64 a[88:89], v210 offset:20480
    s_waitcnt lgkmcnt(14)
    ds_read_b64 a[90:91], v211 offset:20480
    s_waitcnt lgkmcnt(14)
    ds_read_b64 a[92:93], v210 offset:22528
    s_waitcnt lgkmcnt(14)
    ds_read_b64 a[94:95], v211 offset:22528
    s_waitcnt lgkmcnt(0)
    v_lshlrev_b32 v176, 3, v1
    s_lshl_b32 s51, s3, 10
    s_add_u32 s51, s51, 0x0
    v_add_u32 v176, s51, v176
    s_add_u32 s50, s3, 0
    s_and_b32 s50, s50, 3
    s_lshl_b32 s50, s50, 12
    v_add_u32 v177, s50, v176
    s_lshr_b32 s67, s68, 1
    s_add_u32 s67, s67, 3
    s_and_b32 s67, s67, 7
    s_lshl_b32 s67, s67, 7
    s_add_u32 s67, s67, s57
    s_add_u32 m0, s56, 0x0
    s_nop 0
    buffer_load_dwordx4 v200, s[40:43], s67 offen lds
    v_pk_mul_f32 v[160:161], v[10:11], v[150:151] op_sel:[0,1] op_sel_hi:[1,1]
    v_pk_mul_f32 v[168:169], v[12:13], v[150:151] op_sel:[0,1] op_sel_hi:[1,1]
    v_pk_fma_f32 v[64:65], v[64:65], v[150:151], v[160:161] op_sel_hi:[1,0,1] neg_lo:[0,0,1] neg_hi:[0,0,1]
    v_pk_fma_f32 v[66:67], v[66:67], v[150:151], v[168:169] op_sel_hi:[1,0,1] neg_lo:[0,0,1] neg_hi:[0,0,1]
    v_pk_mul_f32 v[160:161], v[64:65], v[64:65]
    v_pk_mul_f32 v[168:169], v[66:67], v[66:67]
    v_pk_fma_f32 v[160:161], v[160:161], s[62:63], v[162:163]
    v_pk_fma_f32 v[168:169], v[168:169], s[62:63], v[170:171]
    v_pk_mul_f32 v[160:161], v[160:161], v[64:65]
    v_pk_mul_f32 v[168:169], v[168:169], v[66:67]
    v_exp_f32 v160, v160
    v_exp_f32 v161, v161
    v_exp_f32 v168, v168
    v_exp_f32 v169, v169
    s_add_u32 m0, s56, 0x400
    s_nop 0
    buffer_load_dwordx4 v201, s[40:43], s67 offen lds
    s_nop 0
    v_pk_add_f32 v[160:161], v[160:161], v[164:165]
    v_pk_add_f32 v[168:169], v[168:169], v[172:173]
    v_rcp_f32 v160, v160
    v_rcp_f32 v161, v161
    v_rcp_f32 v168, v168
    v_rcp_f32 v169, v169
    s_add_u32 m0, s56, 0x800
    s_nop 0
    buffer_load_dwordx4 v202, s[40:43], s67 offen lds
    s_nop 0
    v_pk_mul_f32 v[64:65], v[64:65], v[160:161]
    v_pk_mul_f32 v[66:67], v[66:67], v[168:169]
    v_cvt_pk_bf16_f32 v64, v64, v65
    v_cvt_pk_bf16_f32 v65, v66, v67
    ds_write_b64 v177, v[64:65] offset:0
    s_add_u32 m0, s56, 0xc00
    s_nop 0
    buffer_load_dwordx4 v203, s[40:43], s67 offen lds
    v_pk_mul_f32 v[160:161], v[14:15], v[150:151] op_sel:[0,1] op_sel_hi:[1,1]
    v_pk_mul_f32 v[168:169], v[16:17], v[150:151] op_sel:[0,1] op_sel_hi:[1,1]
    v_pk_fma_f32 v[80:81], v[80:81], v[150:151], v[160:161] op_sel_hi:[1,0,1] neg_lo:[0,0,1] neg_hi:[0,0,1]
    v_pk_fma_f32 v[82:83], v[82:83], v[150:151], v[168:169] op_sel_hi:[1,0,1] neg_lo:[0,0,1] neg_hi:[0,0,1]
    v_pk_mul_f32 v[160:161], v[80:81], v[80:81]
    v_pk_mul_f32 v[168:169], v[82:83], v[82:83]
    v_pk_fma_f32 v[160:161], v[160:161], s[62:63], v[162:163]
    v_pk_fma_f32 v[168:169], v[168:169], s[62:63], v[170:171]
    v_pk_mul_f32 v[160:161], v[160:161], v[80:81]
    v_pk_mul_f32 v[168:169], v[168:169], v[82:83]
    v_exp_f32 v160, v160
    v_exp_f32 v161, v161
    v_exp_f32 v168, v168
    v_exp_f32 v169, v169
    s_add_u32 m0, s56, 0x1000
    s_nop 0
    buffer_load_dwordx4 v204, s[40:43], s67 offen lds
    s_nop 0
    v_pk_add_f32 v[160:161], v[160:161], v[164:165]
    v_pk_add_f32 v[168:169], v[168:169], v[172:173]
    v_rcp_f32 v160, v160
    v_rcp_f32 v161, v161
    v_rcp_f32 v168, v168
    v_rcp_f32 v169, v169
    s_add_u32 m0, s56, 0x1400
    s_nop 0
    buffer_load_dwordx4 v205, s[40:43], s67 offen lds
    s_nop 0
    v_pk_mul_f32 v[80:81], v[80:81], v[160:161]
    v_pk_mul_f32 v[82:83], v[82:83], v[168:169]
    v_cvt_pk_bf16_f32 v80, v80, v81
    v_cvt_pk_bf16_f32 v81, v82, v83
    ds_write_b64 v177, v[80:81] offset:512
    s_add_u32 s50, s3, 1
    s_and_b32 s50, s50, 3
    s_lshl_b32 s50, s50, 12
    v_add_u32 v177, s50, v176
    s_add_u32 m0, s56, 0x1800
    s_nop 0
    buffer_load_dwordx4 v206, s[40:43], s67 offen lds
    v_pk_mul_f32 v[160:161], v[10:11], v[152:153] op_sel:[0,1] op_sel_hi:[1,1]
    v_pk_mul_f32 v[168:169], v[12:13], v[152:153] op_sel:[0,1] op_sel_hi:[1,1]
    v_pk_fma_f32 v[68:69], v[68:69], v[152:153], v[160:161] op_sel_hi:[1,0,1] neg_lo:[0,0,1] neg_hi:[0,0,1]
    v_pk_fma_f32 v[70:71], v[70:71], v[152:153], v[168:169] op_sel_hi:[1,0,1] neg_lo:[0,0,1] neg_hi:[0,0,1]
    v_pk_mul_f32 v[160:161], v[68:69], v[68:69]
    v_pk_mul_f32 v[168:169], v[70:71], v[70:71]
    v_pk_fma_f32 v[160:161], v[160:161], s[62:63], v[162:163]
    v_pk_fma_f32 v[168:169], v[168:169], s[62:63], v[170:171]
    v_pk_mul_f32 v[160:161], v[160:161], v[68:69]
    v_pk_mul_f32 v[168:169], v[168:169], v[70:71]
    v_exp_f32 v160, v160
    v_exp_f32 v161, v161
    v_exp_f32 v168, v168
    v_exp_f32 v169, v169
    s_add_u32 m0, s56, 0x1c00
    s_nop 0
    buffer_load_dwordx4 v207, s[40:43], s67 offen lds
    s_nop 0
    v_pk_add_f32 v[160:161], v[160:161], v[164:165]
    v_pk_add_f32 v[168:169], v[168:169], v[172:173]
    v_rcp_f32 v160, v160
    v_rcp_f32 v161, v161
    v_rcp_f32 v168, v168
    v_rcp_f32 v169, v169
    s_lshr_b32 s67, s68, 1
    s_add_u32 s67, s67, 4
    s_and_b32 s67, s67, 7
    s_lshl_b32 s67, s67, 7
    s_add_u32 s67, s67, s57
    s_add_u32 m0, s56, 0x2000
    s_nop 0
    buffer_load_dwordx4 v200, s[40:43], s67 offen lds
    s_nop 0
    v_pk_mul_f32 v[68:69], v[68:69], v[160:161]
    v_pk_mul_f32 v[70:71], v[70:71], v[168:169]
    v_cvt_pk_bf16_f32 v68, v68, v69
    v_cvt_pk_bf16_f32 v69, v70, v71
    ds_write_b64 v177, v[68:69] offset:0
    s_add_u32 m0, s56, 0x2400
    s_nop 0
    buffer_load_dwordx4 v201, s[40:43], s67 offen lds
    v_pk_mul_f32 v[160:161], v[14:15], v[152:153] op_sel:[0,1] op_sel_hi:[1,1]
    v_pk_mul_f32 v[168:169], v[16:17], v[152:153] op_sel:[0,1] op_sel_hi:[1,1]
    v_pk_fma_f32 v[84:85], v[84:85], v[152:153], v[160:161] op_sel_hi:[1,0,1] neg_lo:[0,0,1] neg_hi:[0,0,1]
    v_pk_fma_f32 v[86:87], v[86:87], v[152:153], v[168:169] op_sel_hi:[1,0,1] neg_lo:[0,0,1] neg_hi:[0,0,1]
    v_pk_mul_f32 v[160:161], v[84:85], v[84:85]
    v_pk_mul_f32 v[168:169], v[86:87], v[86:87]
    v_pk_fma_f32 v[160:161], v[160:161], s[62:63], v[162:163]
    v_pk_fma_f32 v[168:169], v[168:169], s[62:63], v[170:171]
    v_pk_mul_f32 v[160:161], v[160:161], v[84:85]
    v_pk_mul_f32 v[168:169], v[168:169], v[86:87]
    v_exp_f32 v160, v160
    v_exp_f32 v161, v161
    v_exp_f32 v168, v168
    v_exp_f32 v169, v169
    s_add_u32 m0, s56, 0x2800
    s_nop 0
    buffer_load_dwordx4 v202, s[40:43], s67 offen lds
    s_nop 0
    v_pk_add_f32 v[160:161], v[160:161], v[164:165]
    v_pk_add_f32 v[168:169], v[168:169], v[172:173]
    v_rcp_f32 v160, v160
    v_rcp_f32 v161, v161
    v_rcp_f32 v168, v168
    v_rcp_f32 v169, v169
    s_add_u32 m0, s56, 0x2c00
    s_nop 0
    buffer_load_dwordx4 v203, s[40:43], s67 offen lds
    s_nop 0
    v_pk_mul_f32 v[84:85], v[84:85], v[160:161]
    v_pk_mul_f32 v[86:87], v[86:87], v[168:169]
    v_cvt_pk_bf16_f32 v84, v84, v85
    v_cvt_pk_bf16_f32 v85, v86, v87
    ds_write_b64 v177, v[84:85] offset:512
    s_add_u32 s50, s3, 2
    s_and_b32 s50, s50, 3
    s_lshl_b32 s50, s50, 12
    v_add_u32 v177, s50, v176
    s_add_u32 m0, s56, 0x3000
    s_nop 0
    buffer_load_dwordx4 v204, s[40:43], s67 offen lds
    v_pk_mul_f32 v[160:161], v[10:11], v[154:155] op_sel:[0,1] op_sel_hi:[1,1]
    v_pk_mul_f32 v[168:169], v[12:13], v[154:155] op_sel:[0,1] op_sel_hi:[1,1]
    v_pk_fma_f32 v[72:73], v[72:73], v[154:155], v[160:161] op_sel_hi:[1,0,1] neg_lo:[0,0,1] neg_hi:[0,0,1]
    v_pk_fma_f32 v[74:75], v[74:75], v[154:155], v[168:169] op_sel_hi:[1,0,1] neg_lo:[0,0,1] neg_hi:[0,0,1]
    v_pk_mul_f32 v[160:161], v[72:73], v[72:73]
    v_pk_mul_f32 v[168:169], v[74:75], v[74:75]
    v_pk_fma_f32 v[160:161], v[160:161], s[62:63], v[162:163]
    v_pk_fma_f32 v[168:169], v[168:169], s[62:63], v[170:171]
    v_pk_mul_f32 v[160:161], v[160:161], v[72:73]
    v_pk_mul_f32 v[168:169], v[168:169], v[74:75]
    v_exp_f32 v160, v160
    v_exp_f32 v161, v161
    v_exp_f32 v168, v168
    v_exp_f32 v169, v169
    s_add_u32 m0, s56, 0x3400
    s_nop 0
    buffer_load_dwordx4 v205, s[40:43], s67 offen lds
    s_nop 0
    v_pk_add_f32 v[160:161], v[160:161], v[164:165]
    v_pk_add_f32 v[168:169], v[168:169], v[172:173]
    v_rcp_f32 v160, v160
    v_rcp_f32 v161, v161
    v_rcp_f32 v168, v168
    v_rcp_f32 v169, v169
    s_add_u32 m0, s56, 0x3800
    s_nop 0
    buffer_load_dwordx4 v206, s[40:43], s67 offen lds
    s_nop 0
    v_pk_mul_f32 v[72:73], v[72:73], v[160:161]
    v_pk_mul_f32 v[74:75], v[74:75], v[168:169]
    v_cvt_pk_bf16_f32 v72, v72, v73
    v_cvt_pk_bf16_f32 v73, v74, v75
    ds_write_b64 v177, v[72:73] offset:0
    s_add_u32 m0, s56, 0x3c00
    s_nop 0
    buffer_load_dwordx4 v207, s[40:43], s67 offen lds
    v_pk_mul_f32 v[160:161], v[14:15], v[154:155] op_sel:[0,1] op_sel_hi:[1,1]
    v_pk_mul_f32 v[168:169], v[16:17], v[154:155] op_sel:[0,1] op_sel_hi:[1,1]
    v_pk_fma_f32 v[88:89], v[88:89], v[154:155], v[160:161] op_sel_hi:[1,0,1] neg_lo:[0,0,1] neg_hi:[0,0,1]
    v_pk_fma_f32 v[90:91], v[90:91], v[154:155], v[168:169] op_sel_hi:[1,0,1] neg_lo:[0,0,1] neg_hi:[0,0,1]
    v_pk_mul_f32 v[160:161], v[88:89], v[88:89]
    v_pk_mul_f32 v[168:169], v[90:91], v[90:91]
    v_pk_fma_f32 v[160:161], v[160:161], s[62:63], v[162:163]
    v_pk_fma_f32 v[168:169], v[168:169], s[62:63], v[170:171]
    v_pk_mul_f32 v[160:161], v[160:161], v[88:89]
    v_pk_mul_f32 v[168:169], v[168:169], v[90:91]
    v_exp_f32 v160, v160
    v_exp_f32 v161, v161
    v_exp_f32 v168, v168
    v_exp_f32 v169, v169
    s_lshr_b32 s67, s68, 1
    s_add_u32 s67, s67, 5
    s_and_b32 s67, s67, 7
    s_lshl_b32 s67, s67, 7
    s_add_u32 s67, s67, s57
    s_add_u32 m0, s56, 0x4000
    s_nop 0
    buffer_load_dwordx4 v200, s[40:43], s67 offen lds
    s_nop 0
    v_pk_add_f32 v[160:161], v[160:161], v[164:165]
    v_pk_add_f32 v[168:169], v[168:169], v[172:173]
    v_rcp_f32 v160, v160
    v_rcp_f32 v161, v161
    v_rcp_f32 v168, v168
    v_rcp_f32 v169, v169
    s_add_u32 m0, s56, 0x4400
    s_nop 0
    buffer_load_dwordx4 v201, s[40:43], s67 offen lds
    s_nop 0
    v_pk_mul_f32 v[88:89], v[88:89], v[160:161]
    v_pk_mul_f32 v[90:91], v[90:91], v[168:169]
    v_cvt_pk_bf16_f32 v88, v88, v89
    v_cvt_pk_bf16_f32 v89, v90, v91
    ds_write_b64 v177, v[88:89] offset:512
    v_lshlrev_b32 v198, 3, v1
    s_lshl_b32 s50, s48, 12
    s_add_u32 s50, s50, 0x1520000
    buffer_load_dwordx2 v[180:181], v198, s[32:35], s50 offen offset:0 sc1
    buffer_load_dwordx2 v[182:183], v198, s[32:35], s50 offen offset:512 sc1
    buffer_load_dwordx2 v[184:185], v198, s[32:35], s50 offen offset:1024 sc1
    buffer_load_dwordx2 v[186:187], v198, s[32:35], s50 offen offset:1536 sc1
    buffer_load_dwordx2 v[188:189], v198, s[32:35], s50 offen offset:2048 sc1
    buffer_load_dwordx2 v[190:191], v198, s[32:35], s50 offen offset:2560 sc1
    buffer_load_dwordx2 v[192:193], v198, s[32:35], s50 offen offset:3072 sc1
    buffer_load_dwordx2 v[194:195], v198, s[32:35], s50 offen offset:3584 sc1
    s_add_u32 s50, s3, 3
    s_and_b32 s50, s50, 3
    s_lshl_b32 s50, s50, 12
    v_add_u32 v177, s50, v176
    s_add_u32 m0, s56, 0x4800
    s_nop 0
    buffer_load_dwordx4 v202, s[40:43], s67 offen lds
    v_pk_mul_f32 v[160:161], v[10:11], v[156:157] op_sel:[0,1] op_sel_hi:[1,1]
    v_pk_mul_f32 v[168:169], v[12:13], v[156:157] op_sel:[0,1] op_sel_hi:[1,1]
    v_pk_fma_f32 v[76:77], v[76:77], v[156:157], v[160:161] op_sel_hi:[1,0,1] neg_lo:[0,0,1] neg_hi:[0,0,1]
    v_pk_fma_f32 v[78:79], v[78:79], v[156:157], v[168:169] op_sel_hi:[1,0,1] neg_lo:[0,0,1] neg_hi:[0,0,1]
    v_pk_mul_f32 v[160:161], v[76:77], v[76:77]
    v_pk_mul_f32 v[168:169], v[78:79], v[78:79]
    v_pk_fma_f32 v[160:161], v[160:161], s[62:63], v[162:163]
    v_pk_fma_f32 v[168:169], v[168:169], s[62:63], v[170:171]
    v_pk_mul_f32 v[160:161], v[160:161], v[76:77]
    v_pk_mul_f32 v[168:169], v[168:169], v[78:79]
    v_exp_f32 v160, v160
    v_exp_f32 v161, v161
    v_exp_f32 v168, v168
    v_exp_f32 v169, v169
    s_add_u32 m0, s56, 0x4c00
    s_nop 0
    buffer_load_dwordx4 v203, s[40:43], s67 offen lds
    s_nop 0
    v_pk_add_f32 v[160:161], v[160:161], v[164:165]
    v_pk_add_f32 v[168:169], v[168:169], v[172:173]
    v_rcp_f32 v160, v160
    v_rcp_f32 v161, v161
    v_rcp_f32 v168, v168
    v_rcp_f32 v169, v169
    s_add_u32 m0, s56, 0x5000
    s_nop 0
    buffer_load_dwordx4 v204, s[40:43], s67 offen lds
    s_nop 0
    v_pk_mul_f32 v[76:77], v[76:77], v[160:161]
    v_pk_mul_f32 v[78:79], v[78:79], v[168:169]
    v_cvt_pk_bf16_f32 v76, v76, v77
    v_cvt_pk_bf16_f32 v77, v78, v79
    ds_write_b64 v177, v[76:77] offset:0
    s_add_u32 m0, s56, 0x5400
    s_nop 0
    buffer_load_dwordx4 v205, s[40:43], s67 offen lds
    v_pk_mul_f32 v[160:161], v[14:15], v[156:157] op_sel:[0,1] op_sel_hi:[1,1]
    v_pk_mul_f32 v[168:169], v[16:17], v[156:157] op_sel:[0,1] op_sel_hi:[1,1]
    v_pk_fma_f32 v[92:93], v[92:93], v[156:157], v[160:161] op_sel_hi:[1,0,1] neg_lo:[0,0,1] neg_hi:[0,0,1]
    v_pk_fma_f32 v[94:95], v[94:95], v[156:157], v[168:169] op_sel_hi:[1,0,1] neg_lo:[0,0,1] neg_hi:[0,0,1]
    v_pk_mul_f32 v[160:161], v[92:93], v[92:93]
    v_pk_mul_f32 v[168:169], v[94:95], v[94:95]
    v_pk_fma_f32 v[160:161], v[160:161], s[62:63], v[162:163]
    v_pk_fma_f32 v[168:169], v[168:169], s[62:63], v[170:171]
    v_pk_mul_f32 v[160:161], v[160:161], v[92:93]
    v_pk_mul_f32 v[168:169], v[168:169], v[94:95]
    v_exp_f32 v160, v160
    v_exp_f32 v161, v161
    v_exp_f32 v168, v168
    v_exp_f32 v169, v169
    s_add_u32 m0, s56, 0x5800
    s_nop 0
    buffer_load_dwordx4 v206, s[40:43], s67 offen lds
    s_nop 0
    v_pk_add_f32 v[160:161], v[160:161], v[164:165]
    v_pk_add_f32 v[168:169], v[168:169], v[172:173]
    v_rcp_f32 v160, v160
    v_rcp_f32 v161, v161
    v_rcp_f32 v168, v168
    v_rcp_f32 v169, v169
    s_add_u32 m0, s56, 0x5c00
    s_nop 0
    buffer_load_dwordx4 v207, s[40:43], s67 offen lds
    s_nop 0
    v_pk_mul_f32 v[92:93], v[92:93], v[160:161]
    v_pk_mul_f32 v[94:95], v[94:95], v[168:169]
    v_cvt_pk_bf16_f32 v92, v92, v93
    v_cvt_pk_bf16_f32 v93, v94, v95
    ds_write_b64 v177, v[92:93] offset:512
    v_lshlrev_b32 v160, 3, v1
    s_mov_b32 s51, 0
    s_waitcnt vmcnt(6)
    s_branch zpc_27
zp_25:
    s_lshl_b32 s50, s48, 12
    s_add_u32 s50, s50, 0x1520000
    buffer_load_dwordx2 v[180:181], v198, s[32:35], s50 offen offset:0 sc1
    buffer_load_dwordx2 v[182:183], v198, s[32:35], s50 offen offset:512 sc1
    buffer_load_dwordx2 v[184:185], v198, s[32:35], s50 offen offset:1024 sc1
    buffer_load_dwordx2 v[186:187], v198, s[32:35], s50 offen offset:1536 sc1
    buffer_load_dwordx2 v[188:189], v198, s[32:35], s50 offen offset:2048 sc1
    buffer_load_dwordx2 v[190:191], v198, s[32:35], s50 offen offset:2560 sc1
    buffer_load_dwordx2 v[192:193], v198, s[32:35], s50 offen offset:3072 sc1
    buffer_load_dwordx2 v[194:195], v198, s[32:35], s50 offen offset:3584 sc1
    s_waitcnt vmcnt(0)
zpc_27:
    v_min_f32 v161, v181, v183
    v_min_f32 v161, v161, v185
    v_min_f32 v161, v161, v187
    v_min_f32 v161, v161, v189
    v_min_f32 v161, v161, v191
    v_min_f32 v161, v161, v193
    v_min_f32 v161, v161, v195
    v_cmp_gt_f32 vcc, 0, v161
    s_nop 1
    s_cmp_eq_u64 vcc, 0
    s_cbranch_scc1 zpd_26
    s_add_u32 s51, s51, 1
    s_cmp_lt_u32 s51, 0x100000
    s_cbranch_scc1 zp_25
zpd_26:
    v_pk_add_f32 v[180:181], v[180:181], v[182:183]
    v_pk_add_f32 v[180:181], v[180:181], v[184:185]
    v_pk_add_f32 v[180:181], v[180:181], v[186:187]
    v_pk_add_f32 v[180:181], v[180:181], v[188:189]
    v_pk_add_f32 v[180:181], v[180:181], v[190:191]
    v_pk_add_f32 v[180:181], v[180:181], v[192:193]
    v_pk_add_f32 v[180:181], v[180:181], v[194:195]
    v_mul_f32 v180, 0x3a924925, v180
    v_mul_f32 v181, 0x3a924925, v181
    v_fma_f32 v181, -v180, v180, v181
    v_max_f32 v181, 0, v181
    v_add_f32 v181, 0x3727c5ac, v181
    v_rsq_f32 v182, v181
    s_nop 0
    v_mul_f32 v183, v180, v182
    v_sub_f32 v183, 0, v183
    s_lshl_b32 s50, s3, 9
    s_add_u32 s50, s50, 0xb000
    v_add_u32 v161, s50, v160
    ds_write_b64 v161, v[182:183]
    s_waitcnt lgkmcnt(0)
    v_lshlrev_b32 v162, 3, v27
    v_add_u32 v162, s50, v162
    s_add_u32 s51, s3, 0
    s_and_b32 s51, s51, 3
    s_lshl_b32 s51, s51, 7
    v_add_u32 v163, s51, v162
    ds_read_b64 v[150:151], v163
    s_add_u32 s51, s3, 1
    s_and_b32 s51, s51, 3
    s_lshl_b32 s51, s51, 7
    v_add_u32 v163, s51, v162
    ds_read_b64 v[152:153], v163
    s_add_u32 s51, s3, 2
    s_and_b32 s51, s51, 3
    s_lshl_b32 s51, s51, 7
    v_add_u32 v163, s51, v162
    ds_read_b64 v[154:155], v163
    s_add_u32 s51, s3, 3
    s_and_b32 s51, s51, 3
    s_lshl_b32 s51, s51, 7
    v_add_u32 v163, s51, v162
    ds_read_b64 v[156:157], v163
    s_waitcnt lgkmcnt(0)
    s_mul_i32 s50, s3, 5120
    s_add_u32 s50, s50, 0x4000
    v_mul_u32_u24 v164, 40, v27
    v_lshl_add_u32 v164, v28, 3, v164
    v_add_u32 v164, s50, v164
    s_add_u32 s51, s3, 0
    s_and_b32 s51, s51, 3
    s_mul_i32 s51, s51, 640
    v_add_u32 v165, s51, v164
    v_pk_fma_f32 v[32:33], v[32:33], v[150:151], v[150:151] op_sel:[0,0,1] op_sel_hi:[1,0,1]
    v_pk_fma_f32 v[34:35], v[34:35], v[150:151], v[150:151] op_sel:[0,0,1] op_sel_hi:[1,0,1]
    v_cvt_pk_bf16_f32 v32, v32, v33
    v_cvt_pk_bf16_f32 v33, v34, v35
    ds_write_b64 v165, v[32:33] offset:0
    v_pk_fma_f32 v[48:49], v[48:49], v[150:151], v[150:151] op_sel:[0,0,1] op_sel_hi:[1,0,1]
    v_pk_fma_f32 v[50:51], v[50:51], v[150:151], v[150:151] op_sel:[0,0,1] op_sel_hi:[1,0,1]
    v_cvt_pk_bf16_f32 v48, v48, v49
    v_cvt_pk_bf16_f32 v49, v50, v51
    ds_write_b64 v165, v[48:49] offset:2560
    s_add_u32 s51, s3, 1
    s_and_b32 s51, s51, 3
    s_mul_i32 s51, s51, 640
    v_add_u32 v165, s51, v164
    v_pk_fma_f32 v[36:37], v[36:37], v[152:153], v[152:153] op_sel:[0,0,1] op_sel_hi:[1,0,1]
    v_pk_fma_f32 v[38:39], v[38:39], v[152:153], v[152:153] op_sel:[0,0,1] op_sel_hi:[1,0,1]
    v_cvt_pk_bf16_f32 v36, v36, v37
    v_cvt_pk_bf16_f32 v37, v38, v39
    ds_write_b64 v165, v[36:37] offset:0
    v_pk_fma_f32 v[52:53], v[52:53], v[152:153], v[152:153] op_sel:[0,0,1] op_sel_hi:[1,0,1]
    v_pk_fma_f32 v[54:55], v[54:55], v[152:153], v[152:153] op_sel:[0,0,1] op_sel_hi:[1,0,1]
    v_cvt_pk_bf16_f32 v52, v52, v53
    v_cvt_pk_bf16_f32 v53, v54, v55
    ds_write_b64 v165, v[52:53] offset:2560
    s_add_u32 s51, s3, 2
    s_and_b32 s51, s51, 3
    s_mul_i32 s51, s51, 640
    v_add_u32 v165, s51, v164
    v_pk_fma_f32 v[40:41], v[40:41], v[154:155], v[154:155] op_sel:[0,0,1] op_sel_hi:[1,0,1]
    v_pk_fma_f32 v[42:43], v[42:43], v[154:155], v[154:155] op_sel:[0,0,1] op_sel_hi:[1,0,1]
    v_cvt_pk_bf16_f32 v40, v40, v41
    v_cvt_pk_bf16_f32 v41, v42, v43
    ds_write_b64 v165, v[40:41] offset:0
    v_pk_fma_f32 v[56:57], v[56:57], v[154:155], v[154:155] op_sel:[0,0,1] op_sel_hi:[1,0,1]
    v_pk_fma_f32 v[58:59], v[58:59], v[154:155], v[154:155] op_sel:[0,0,1] op_sel_hi:[1,0,1]
    v_cvt_pk_bf16_f32 v56, v56, v57
    v_cvt_pk_bf16_f32 v57, v58, v59
    ds_write_b64 v165, v[56:57] offset:2560
    s_add_u32 s51, s3, 3
    s_and_b32 s51, s51, 3
    s_mul_i32 s51, s51, 640
    v_add_u32 v165, s51, v164
    v_pk_fma_f32 v[44:45], v[44:45], v[156:157], v[156:157] op_sel:[0,0,1] op_sel_hi:[1,0,1]
    v_pk_fma_f32 v[46:47], v[46:47], v[156:157], v[156:157] op_sel:[0,0,1] op_sel_hi:[1,0,1]
    v_cvt_pk_bf16_f32 v44, v44, v45
    v_cvt_pk_bf16_f32 v45, v46, v47
    ds_write_b64 v165, v[44:45] offset:0
    v_pk_fma_f32 v[60:61], v[60:61], v[156:157], v[156:157] op_sel:[0,0,1] op_sel_hi:[1,0,1]
    v_pk_fma_f32 v[62:63], v[62:63], v[156:157], v[156:157] op_sel:[0,0,1] op_sel_hi:[1,0,1]
    v_cvt_pk_bf16_f32 v60, v60, v61
    v_cvt_pk_bf16_f32 v61, v62, v63
    ds_write_b64 v165, v[60:61] offset:2560
    s_waitcnt lgkmcnt(0)
    v_lshrrev_b32 v164, 2, v27
    v_lshl_add_u32 v164, v28, 2, v164
    v_mul_u32_u24 v164, 40, v164
    v_and_b32 v165, 3, v1
    v_lshl_add_u32 v164, v165, 3, v164
    v_add_u32 v164, s50, v164
    ds_read_b64_tr_b16 v[96:97], v164 offset:0
    ds_read_b64_tr_b16 v[98:99], v164 offset:640
    ds_read_b64_tr_b16 v[100:101], v164 offset:1280
    ds_read_b64_tr_b16 v[102:103], v164 offset:1920
    ds_read_b64_tr_b16 v[104:105], v164 offset:2560
    ds_read_b64_tr_b16 v[106:107], v164 offset:3200
    ds_read_b64_tr_b16 v[108:109], v164 offset:3840
    ds_read_b64_tr_b16 v[110:111], v164 offset:4480
    s_lshl_b32 s50, s49, 6
    s_lshl_b32 s51, s48, 1
    s_add_u32 s50, s50, s51
    s_mul_i32 s50, s50, 7
    s_lshl_b32 s51, s3, 1
    s_add_u32 s50, s50, s51
    s_lshl_b32 s50, s50, 10
    s_add_u32 s50, s50, 0xa00000
    v_lshlrev_b32 v165, 4, v1
    v_add_u32 v166, 0x40000000, v165
    s_cmp_eq_u32 s3, 3
    s_cselect_b64 vcc, -1, 0
    v_cndmask_b32 v166, v165, v166, vcc
    s_add_u32 s51, s50, 0
    s_waitcnt lgkmcnt(6)
    buffer_store_dwordx4 v[96:99], v165, s[32:35], s51 offen offset:0 sc1
    s_add_u32 s51, s50, 7168
    s_waitcnt lgkmcnt(4)
    buffer_store_dwordx4 v[100:103], v165, s[32:35], s51 offen offset:0 sc1
    s_add_u32 s51, s50, 1024
    s_waitcnt lgkmcnt(2)
    buffer_store_dwordx4 v[104:107], v166, s[32:35], s51 offen offset:0 sc1
    s_add_u32 s51, s50, 8192
    s_waitcnt lgkmcnt(0)
    buffer_store_dwordx4 v[108:111], v166, s[32:35], s51 offen offset:0 sc1
    ds_read_b64 a[96:97], v208 offset:0
    ds_read_b64 a[98:99], v209 offset:0
    ds_read_b64 a[100:101], v208 offset:2048
    ds_read_b64 a[102:103], v209 offset:2048
    ds_read_b64 a[104:105], v208 offset:4096
    ds_read_b64 a[106:107], v209 offset:4096
    ds_read_b64 a[108:109], v208 offset:6144
    ds_read_b64 a[110:111], v209 offset:6144
    ds_read_b64 a[112:113], v210 offset:0
    ds_read_b64 a[114:115], v211 offset:0
    ds_read_b64 a[116:117], v210 offset:2048
    ds_read_b64 a[118:119], v211 offset:2048
    ds_read_b64 a[120:121], v210 offset:4096
    ds_read_b64 a[122:123], v211 offset:4096
    ds_read_b64 a[124:125], v210 offset:6144
    s_waitcnt lgkmcnt(14)
    ds_read_b64 a[126:127], v211 offset:6144
    s_waitcnt lgkmcnt(14)
    ds_read_b64 a[128:129], v208 offset:8192
    s_waitcnt lgkmcnt(14)
    ds_read_b64 a[130:131], v209 offset:8192
    s_waitcnt lgkmcnt(14)
    ds_read_b64 a[132:133], v208 offset:10240
    s_waitcnt lgkmcnt(14)
    ds_read_b64 a[134:135], v209 offset:10240
    s_waitcnt lgkmcnt(14)
    ds_read_b64 a[136:137], v208 offset:12288
    s_waitcnt lgkmcnt(14)
    ds_read_b64 a[138:139], v209 offset:12288
    s_waitcnt lgkmcnt(14)
    ds_read_b64 a[140:141], v208 offset:14336
    s_waitcnt lgkmcnt(14)
    ds_read_b64 a[142:143], v209 offset:14336
    s_waitcnt lgkmcnt(14)
    ds_read_b64 a[144:145], v210 offset:8192
    s_waitcnt lgkmcnt(14)
    ds_read_b64 a[146:147], v211 offset:8192
    s_waitcnt lgkmcnt(14)
    ds_read_b64 a[148:149], v210 offset:10240
    s_waitcnt lgkmcnt(14)
    ds_read_b64 a[150:151], v211 offset:10240
    s_waitcnt lgkmcnt(14)
    ds_read_b64 a[152:153], v210 offset:12288
    s_waitcnt lgkmcnt(14)
    ds_read_b64 a[154:155], v211 offset:12288
    s_waitcnt lgkmcnt(14)
    ds_read_b64 a[156:157], v210 offset:14336
    s_waitcnt lgkmcnt(14)
    ds_read_b64 a[158:159], v211 offset:14336
    s_waitcnt vmcnt(4)
    s_waitcnt lgkmcnt(14)
    ds_read_b64 a[160:161], v208 offset:16384
    s_waitcnt lgkmcnt(14)
    ds_read_b64 a[162:163], v209 offset:16384
    s_waitcnt lgkmcnt(14)
    ds_read_b64 a[164:165], v208 offset:18432
    s_waitcnt lgkmcnt(14)
    ds_read_b64 a[166:167], v209 offset:18432
    s_waitcnt lgkmcnt(14)
    ds_read_b64 a[168:169], v208 offset:20480
    s_waitcnt lgkmcnt(14)
    ds_read_b64 a[170:171], v209 offset:20480
    s_waitcnt lgkmcnt(14)
    ds_read_b64 a[172:173], v208 offset:22528
    s_waitcnt lgkmcnt(14)
    ds_read_b64 a[174:175], v209 offset:22528
    s_waitcnt lgkmcnt(14)
    ds_read_b64 a[176:177], v210 offset:16384
    s_waitcnt lgkmcnt(14)
    ds_read_b64 a[178:179], v211 offset:16384
    s_waitcnt lgkmcnt(14)
    ds_read_b64 a[180:181], v210 offset:18432
    s_waitcnt lgkmcnt(14)
    ds_read_b64 a[182:183], v211 offset:18432
    s_waitcnt lgkmcnt(14)
    ds_read_b64 a[184:185], v210 offset:20480
    s_waitcnt lgkmcnt(14)
    ds_read_b64 a[186:187], v211 offset:20480
    s_waitcnt lgkmcnt(14)
    ds_read_b64 a[188:189], v210 offset:22528
    s_waitcnt lgkmcnt(14)
    ds_read_b64 a[190:191], v211 offset:22528
    s_waitcnt lgkmcnt(0)
    s_lshr_b32 s67, s68, 1
    s_add_u32 s67, s67, 6
    s_and_b32 s67, s67, 7
    s_lshl_b32 s67, s67, 7
    s_add_u32 s67, s67, s57
    s_add_u32 m0, s56, 0x0
    s_nop 0
    buffer_load_dwordx4 v200, s[40:43], s67 offen lds
    s_add_u32 m0, s56, 0x400
    s_nop 0
    buffer_load_dwordx4 v201, s[40:43], s67 offen lds
    s_add_u32 m0, s56, 0x800
    s_nop 0
    buffer_load_dwordx4 v202, s[40:43], s67 offen lds
    s_add_u32 m0, s56, 0xc00
    s_nop 0
    buffer_load_dwordx4 v203, s[40:43], s67 offen lds
    s_add_u32 m0, s56, 0x1000
    s_nop 0
    buffer_load_dwordx4 v204, s[40:43], s67 offen lds
    s_add_u32 m0, s56, 0x1400
    s_nop 0
    buffer_load_dwordx4 v205, s[40:43], s67 offen lds
    s_add_u32 m0, s56, 0x1800
    s_nop 0
    buffer_load_dwordx4 v206, s[40:43], s67 offen lds
    s_add_u32 m0, s56, 0x1c00
    s_nop 0
    buffer_load_dwordx4 v207, s[40:43], s67 offen lds
    s_waitcnt vmcnt(8)
    s_waitcnt lgkmcnt(0)
    s_barrier
    s_cmp_eq_u32 s3, 0
    s_cbranch_scc0 arr_28
    s_lshl_b32 s50, s49, 8
    s_add_u32 s50, s50, 0x155c000
    s_mov_b64 s[52:53], exec
    s_mov_b64 exec, 1
    v_mov_b32 v29, s50
    v_mov_b32 v30, 1
    global_atomic_add v29, v30, s[28:29] sc1
    s_mov_b64 exec, s[52:53]
arr_28:
    s_lshr_b32 s67, s68, 1
    s_add_u32 s67, s67, 7
    s_and_b32 s67, s67, 7
    s_lshl_b32 s67, s67, 7
    s_add_u32 s67, s67, s57
    s_add_u32 m0, s56, 0x2000
    s_nop 0
    buffer_load_dwordx4 v200, s[40:43], s67 offen lds
    s_add_u32 m0, s56, 0x2400
    s_nop 0
    buffer_load_dwordx4 v201, s[40:43], s67 offen lds
    s_add_u32 m0, s56, 0x2800
    s_nop 0
    buffer_load_dwordx4 v202, s[40:43], s67 offen lds
    s_add_u32 m0, s56, 0x2c00
    s_nop 0
    buffer_load_dwordx4 v203, s[40:43], s67 offen lds
    s_add_u32 m0, s56, 0x3000
    s_nop 0
    buffer_load_dwordx4 v204, s[40:43], s67 offen lds
    s_add_u32 m0, s56, 0x3400
    s_nop 0
    buffer_load_dwordx4 v205, s[40:43], s67 offen lds
    s_add_u32 m0, s56, 0x3800
    s_nop 0
    buffer_load_dwordx4 v206, s[40:43], s67 offen lds
    s_add_u32 m0, s56, 0x3c00
    s_nop 0
    buffer_load_dwordx4 v207, s[40:43], s67 offen lds
    s_waitcnt vmcnt(8)
    ds_read_b64 a[192:193], v208 offset:0
    ds_read_b64 a[194:195], v209 offset:0
    ds_read_b64 a[196:197], v208 offset:2048
    ds_read_b64 a[198:199], v209 offset:2048
    ds_read_b64 a[200:201], v208 offset:4096
    ds_read_b64 a[202:203], v209 offset:4096
    ds_read_b64 a[204:205], v208 offset:6144
    ds_read_b64 a[206:207], v209 offset:6144
    ds_read_b64 a[208:209], v210 offset:0
    ds_read_b64 a[210:211], v211 offset:0
    ds_read_b64 a[212:213], v210 offset:2048
    ds_read_b64 a[214:215], v211 offset:2048
    ds_read_b64 a[216:217], v210 offset:4096
    ds_read_b64 a[218:219], v211 offset:4096
    ds_read_b64 a[220:221], v210 offset:6144
    s_waitcnt lgkmcnt(14)
    ds_read_b64 a[222:223], v211 offset:6144
    s_waitcnt vmcnt(0)
    s_waitcnt lgkmcnt(14)
    ds_read_b64 a[224:225], v208 offset:8192
    s_waitcnt lgkmcnt(14)
    ds_read_b64 a[226:227], v209 offset:8192
    s_waitcnt lgkmcnt(14)
    ds_read_b64 a[228:229], v208 offset:10240
    s_waitcnt lgkmcnt(14)
    ds_read_b64 a[230:231], v209 offset:10240
    s_waitcnt lgkmcnt(14)
    ds_read_b64 a[232:233], v208 offset:12288
    s_waitcnt lgkmcnt(14)
    ds_read_b64 a[234:235], v209 offset:12288
    s_waitcnt lgkmcnt(14)
    ds_read_b64 a[236:237], v208 offset:14336
    s_waitcnt lgkmcnt(14)
    ds_read_b64 a[238:239], v209 offset:14336
    s_waitcnt lgkmcnt(14)
    ds_read_b64 a[240:241], v210 offset:8192
    s_waitcnt lgkmcnt(14)
    ds_read_b64 a[242:243], v211 offset:8192
    s_waitcnt lgkmcnt(14)
    ds_read_b64 a[244:245], v210 offset:10240
    s_waitcnt lgkmcnt(14)
    ds_read_b64 a[246:247], v211 offset:10240
    s_waitcnt lgkmcnt(14)
    ds_read_b64 a[248:249], v210 offset:12288
    s_waitcnt lgkmcnt(14)
    ds_read_b64 a[250:251], v211 offset:12288
    s_waitcnt lgkmcnt(14)
    ds_read_b64 a[252:253], v210 offset:14336
    s_waitcnt lgkmcnt(14)
    ds_read_b64 a[254:255], v211 offset:14336
    s_waitcnt lgkmcnt(0)
    s_cmp_eq_u32 s3, 0
    s_cbranch_scc0 pskip_29
    s_lshl_b32 s50, s49, 8
    s_add_u32 s50, s50, 0x155c000
    s_mov_b64 s[52:53], exec
    v_lshlrev_b32 v29, 8, v1
    v_add_u32 v29, s50, v29
    s_mov_b64 exec, 0x1
    s_mov_b32 s51, 0
ploop_30:
    global_load_dword v30, v29, s[28:29] sc1
    s_waitcnt vmcnt(0)
    v_cmp_gt_u32 vcc, 32, v30
    s_nop 1
    s_cmp_eq_u64 vcc, 0
    s_cbranch_scc1 pdone_31
    s_add_u32 s51, s51, 1
    s_cmp_lt_u32 s51, 0x200000
    s_cbranch_scc1 ploop_30
pdone_31:
    s_mov_b64 exec, s[52:53]
pskip_29:
    s_barrier
    v_lshlrev_b32 v31, 4, v1
    s_lshr_b32 s58, s49, 1
    s_lshl_b32 s58, s58, 2
    s_add_u32 s58, s58, s3
    s_mul_i32 s58, s58, 57344
    s_add_u32 s58, s58, 0x1400000
    v_lshlrev_b32 v29, 4, v1
    v_add_u32 v30, 0x1000, v29
    s_lshl_b32 s56, s49, 6
    s_lshl_b32 s57, s3, 4
    s_add_u32 s56, s56, s57
    s_mul_i32 s56, s56, 7168
    s_add_u32 s56, s56, 0xa00000
    s_add_u32 s57, s68, 0
    s_and_b32 s57, s57, 15
    s_mul_i32 s57, s57, 7168
    s_add_u32 s57, s57, s56
    buffer_load_dwordx4 v[144:147], v29, s[32:35], s57 offen offset:0 sc1
    buffer_load_dwordx4 v[148:151], v29, s[32:35], s57 offen offset:1024 sc1
    buffer_load_dwordx4 v[152:155], v29, s[32:35], s57 offen offset:2048 sc1
    buffer_load_dwordx4 v[156:159], v29, s[32:35], s57 offen offset:3072 sc1
    buffer_load_dwordx4 v[160:163], v30, s[32:35], s57 offen offset:0 sc1
    buffer_load_dwordx4 v[164:167], v30, s[32:35], s57 offen offset:1024 sc1
    buffer_load_dwordx4 v[168:171], v30, s[32:35], s57 offen offset:2048 sc1
    s_add_u32 s57, s68, 1
    s_and_b32 s57, s57, 15
    s_mul_i32 s57, s57, 7168
    s_add_u32 s57, s57, s56
    buffer_load_dwordx4 v[172:175], v29, s[32:35], s57 offen offset:0 sc1
    buffer_load_dwordx4 v[176:179], v29, s[32:35], s57 offen offset:1024 sc1
    buffer_load_dwordx4 v[180:183], v29, s[32:35], s57 offen offset:2048 sc1
    buffer_load_dwordx4 v[184:187], v29, s[32:35], s57 offen offset:3072 sc1
    buffer_load_dwordx4 v[188:191], v30, s[32:35], s57 offen offset:0 sc1
    buffer_load_dwordx4 v[192:195], v30, s[32:35], s57 offen offset:1024 sc1
    buffer_load_dwordx4 v[196:199], v30, s[32:35], s57 offen offset:2048 sc1
    s_mul_i32 s52, s3, 24576
    s_add_u32 s52, s52, 65536
    v_lshlrev_b32 v3, 4, v1
    v_add_u32 v2, s52, v3
    s_waitcnt vmcnt(7)
    v_mfma_f32_16x16x32_bf16 v[32:35], v[144:147], a[0:3], 0
    v_mfma_f32_16x16x32_bf16 v[36:39], v[144:147], a[4:7], 0
    s_add_u32 s57, s68, 2
    s_and_b32 s57, s57, 15
    s_mul_i32 s57, s57, 7168
    s_add_u32 s57, s57, s56
    buffer_load_dwordx4 v[200:203], v29, s[32:35], s57 offen offset:0 sc1
    v_mfma_f32_16x16x32_bf16 v[40:43], v[144:147], a[8:11], 0
    v_mfma_f32_16x16x32_bf16 v[44:47], v[144:147], a[12:15], 0
    buffer_load_dwordx4 v[204:207], v29, s[32:35], s57 offen offset:1024 sc1
    v_mfma_f32_16x16x32_bf16 v[48:51], v[148:151], a[0:3], 0
    v_mfma_f32_16x16x32_bf16 v[52:55], v[148:151], a[4:7], 0
    buffer_load_dwordx4 v[208:211], v29, s[32:35], s57 offen offset:2048 sc1
    v_mfma_f32_16x16x32_bf16 v[56:59], v[148:151], a[8:11], 0
    v_mfma_f32_16x16x32_bf16 v[60:63], v[148:151], a[12:15], 0
    buffer_load_dwordx4 v[212:215], v29, s[32:35], s57 offen offset:3072 sc1
    v_mfma_f32_16x16x32_bf16 v[64:67], v[152:155], a[0:3], 0
    v_mfma_f32_16x16x32_bf16 v[68:71], v[152:155], a[4:7], 0
    buffer_load_dwordx4 v[216:219], v30, s[32:35], s57 offen offset:0 sc1
    v_mfma_f32_16x16x32_bf16 v[72:75], v[152:155], a[8:11], 0
    v_mfma_f32_16x16x32_bf16 v[76:79], v[152:155], a[12:15], 0
    buffer_load_dwordx4 v[220:223], v30, s[32:35], s57 offen offset:1024 sc1
    v_mfma_f32_16x16x32_bf16 v[80:83], v[156:159], a[0:3], 0
    v_mfma_f32_16x16x32_bf16 v[84:87], v[156:159], a[4:7], 0
    buffer_load_dwordx4 v[224:227], v30, s[32:35], s57 offen offset:2048 sc1
    v_mfma_f32_16x16x32_bf16 v[88:91], v[156:159], a[8:11], 0
    v_mfma_f32_16x16x32_bf16 v[92:95], v[156:159], a[12:15], 0
    s_add_u32 s57, s68, 3
    s_and_b32 s57, s57, 15
    s_mul_i32 s57, s57, 7168
    s_add_u32 s57, s57, s56
    buffer_load_dwordx4 v[228:231], v29, s[32:35], s57 offen offset:0 sc1
    v_mfma_f32_16x16x32_bf16 v[96:99], v[160:163], a[0:3], 0
    v_mfma_f32_16x16x32_bf16 v[100:103], v[160:163], a[4:7], 0
    buffer_load_dwordx4 v[232:235], v29, s[32:35], s57 offen offset:1024 sc1
    v_mfma_f32_16x16x32_bf16 v[104:107], v[160:163], a[8:11], 0
    v_mfma_f32_16x16x32_bf16 v[108:111], v[160:163], a[12:15], 0
    buffer_load_dwordx4 v[236:239], v29, s[32:35], s57 offen offset:2048 sc1
    v_mfma_f32_16x16x32_bf16 v[112:115], v[164:167], a[0:3], 0
    v_mfma_f32_16x16x32_bf16 v[116:119], v[164:167], a[4:7], 0
    buffer_load_dwordx4 v[240:243], v29, s[32:35], s57 offen offset:3072 sc1
    v_mfma_f32_16x16x32_bf16 v[120:123], v[164:167], a[8:11], 0
    v_mfma_f32_16x16x32_bf16 v[124:127], v[164:167], a[12:15], 0
    buffer_load_dwordx4 v[244:247], v30, s[32:35], s57 offen offset:0 sc1
    v_mfma_f32_16x16x32_bf16 v[128:131], v[168:171], a[0:3], 0
    v_mfma_f32_16x16x32_bf16 v[132:135], v[168:171], a[4:7], 0
    buffer_load_dwordx4 v[248:251], v30, s[32:35], s57 offen offset:1024 sc1
    v_mfma_f32_16x16x32_bf16 v[136:139], v[168:171], a[8:11], 0
    v_mfma_f32_16x16x32_bf16 v[140:143], v[168:171], a[12:15], 0
    buffer_load_dwordx4 v[252:255], v30, s[32:35], s57 offen offset:2048 sc1
    s_waitcnt vmcnt(14)
    v_mfma_f32_16x16x32_bf16 v[32:35], v[172:175], a[16:19], v[32:35]
    v_mfma_f32_16x16x32_bf16 v[36:39], v[172:175], a[20:23], v[36:39]
    v_mfma_f32_16x16x32_bf16 v[40:43], v[172:175], a[24:27], v[40:43]
    v_mfma_f32_16x16x32_bf16 v[44:47], v[172:175], a[28:31], v[44:47]
    s_add_u32 s57, s68, 4
    s_and_b32 s57, s57, 15
    s_mul_i32 s57, s57, 7168
    s_add_u32 s57, s57, s56
    buffer_load_dwordx4 v[144:147], v29, s[32:35], s57 offen offset:0 sc1
    v_mfma_f32_16x16x32_bf16 v[48:51], v[176:179], a[16:19], v[48:51]
    v_mfma_f32_16x16x32_bf16 v[52:55], v[176:179], a[20:23], v[52:55]
    v_mfma_f32_16x16x32_bf16 v[56:59], v[176:179], a[24:27], v[56:59]
    v_mfma_f32_16x16x32_bf16 v[60:63], v[176:179], a[28:31], v[60:63]
    buffer_load_dwordx4 v[148:151], v29, s[32:35], s57 offen offset:1024 sc1
    v_mfma_f32_16x16x32_bf16 v[64:67], v[180:183], a[16:19], v[64:67]
    v_mfma_f32_16x16x32_bf16 v[68:71], v[180:183], a[20:23], v[68:71]
    v_mfma_f32_16x16x32_bf16 v[72:75], v[180:183], a[24:27], v[72:75]
    v_mfma_f32_16x16x32_bf16 v[76:79], v[180:183], a[28:31], v[76:79]
    buffer_load_dwordx4 v[152:155], v29, s[32:35], s57 offen offset:2048 sc1
    v_mfma_f32_16x16x32_bf16 v[80:83], v[184:187], a[16:19], v[80:83]
    v_mfma_f32_16x16x32_bf16 v[84:87], v[184:187], a[20:23], v[84:87]
    v_mfma_f32_16x16x32_bf16 v[88:91], v[184:187], a[24:27], v[88:91]
    v_mfma_f32_16x16x32_bf16 v[92:95], v[184:187], a[28:31], v[92:95]
    buffer_load_dwordx4 v[156:159], v29, s[32:35], s57 offen offset:3072 sc1
    v_mfma_f32_16x16x32_bf16 v[96:99], v[188:191], a[16:19], v[96:99]
    v_mfma_f32_16x16x32_bf16 v[100:103], v[188:191], a[20:23], v[100:103]
    v_mfma_f32_16x16x32_bf16 v[104:107], v[188:191], a[24:27], v[104:107]
    v_mfma_f32_16x16x32_bf16 v[108:111], v[188:191], a[28:31], v[108:111]
    buffer_load_dwordx4 v[160:163], v30, s[32:35], s57 offen offset:0 sc1
    v_mfma_f32_16x16x32_bf16 v[112:115], v[192:195], a[16:19], v[112:115]
    v_mfma_f32_16x16x32_bf16 v[116:119], v[192:195], a[20:23], v[116:119]
    v_mfma_f32_16x16x32_bf16 v[120:123], v[192:195], a[24:27], v[120:123]
    v_mfma_f32_16x16x32_bf16 v[124:127], v[192:195], a[28:31], v[124:127]
    buffer_load_dwordx4 v[164:167], v30, s[32:35], s57 offen offset:1024 sc1
    v_mfma_f32_16x16x32_bf16 v[128:131], v[196:199], a[16:19], v[128:131]
    v_mfma_f32_16x16x32_bf16 v[132:135], v[196:199], a[20:23], v[132:135]
    v_mfma_f32_16x16x32_bf16 v[136:139], v[196:199], a[24:27], v[136:139]
    v_mfma_f32_16x16x32_bf16 v[140:143], v[196:199], a[28:31], v[140:143]
    buffer_load_dwordx4 v[168:171], v30, s[32:35], s57 offen offset:2048 sc1
    s_waitcnt vmcnt(14)
    v_mfma_f32_16x16x32_bf16 v[32:35], v[200:203], a[32:35], v[32:35]
    v_mfma_f32_16x16x32_bf16 v[36:39], v[200:203], a[36:39], v[36:39]
    v_mfma_f32_16x16x32_bf16 v[40:43], v[200:203], a[40:43], v[40:43]
    v_mfma_f32_16x16x32_bf16 v[44:47], v[200:203], a[44:47], v[44:47]
    s_add_u32 s57, s68, 5
    s_and_b32 s57, s57, 15
    s_mul_i32 s57, s57, 7168
    s_add_u32 s57, s57, s56
    buffer_load_dwordx4 v[172:175], v29, s[32:35], s57 offen offset:0 sc1
    v_mfma_f32_16x16x32_bf16 v[48:51], v[204:207], a[32:35], v[48:51]
    v_mfma_f32_16x16x32_bf16 v[52:55], v[204:207], a[36:39], v[52:55]
    v_mfma_f32_16x16x32_bf16 v[56:59], v[204:207], a[40:43], v[56:59]
    v_mfma_f32_16x16x32_bf16 v[60:63], v[204:207], a[44:47], v[60:63]
    buffer_load_dwordx4 v[176:179], v29, s[32:35], s57 offen offset:1024 sc1
    v_mfma_f32_16x16x32_bf16 v[64:67], v[208:211], a[32:35], v[64:67]
    v_mfma_f32_16x16x32_bf16 v[68:71], v[208:211], a[36:39], v[68:71]
    v_mfma_f32_16x16x32_bf16 v[72:75], v[208:211], a[40:43], v[72:75]
    v_mfma_f32_16x16x32_bf16 v[76:79], v[208:211], a[44:47], v[76:79]
    buffer_load_dwordx4 v[180:183], v29, s[32:35], s57 offen offset:2048 sc1
    v_mfma_f32_16x16x32_bf16 v[80:83], v[212:215], a[32:35], v[80:83]
    v_mfma_f32_16x16x32_bf16 v[84:87], v[212:215], a[36:39], v[84:87]
    v_mfma_f32_16x16x32_bf16 v[88:91], v[212:215], a[40:43], v[88:91]
    v_mfma_f32_16x16x32_bf16 v[92:95], v[212:215], a[44:47], v[92:95]
    buffer_load_dwordx4 v[184:187], v29, s[32:35], s57 offen offset:3072 sc1
    v_mfma_f32_16x16x32_bf16 v[96:99], v[216:219], a[32:35], v[96:99]
    v_mfma_f32_16x16x32_bf16 v[100:103], v[216:219], a[36:39], v[100:103]
    v_mfma_f32_16x16x32_bf16 v[104:107], v[216:219], a[40:43], v[104:107]
    v_mfma_f32_16x16x32_bf16 v[108:111], v[216:219], a[44:47], v[108:111]
    buffer_load_dwordx4 v[188:191], v30, s[32:35], s57 offen offset:0 sc1
    v_mfma_f32_16x16x32_bf16 v[112:115], v[220:223], a[32:35], v[112:115]
    v_mfma_f32_16x16x32_bf16 v[116:119], v[220:223], a[36:39], v[116:119]
    v_mfma_f32_16x16x32_bf16 v[120:123], v[220:223], a[40:43], v[120:123]
    v_mfma_f32_16x16x32_bf16 v[124:127], v[220:223], a[44:47], v[124:127]
    buffer_load_dwordx4 v[192:195], v30, s[32:35], s57 offen offset:1024 sc1
    v_mfma_f32_16x16x32_bf16 v[128:131], v[224:227], a[32:35], v[128:131]
    v_mfma_f32_16x16x32_bf16 v[132:135], v[224:227], a[36:39], v[132:135]
    v_mfma_f32_16x16x32_bf16 v[136:139], v[224:227], a[40:43], v[136:139]
    v_mfma_f32_16x16x32_bf16 v[140:143], v[224:227], a[44:47], v[140:143]
    buffer_load_dwordx4 v[196:199], v30, s[32:35], s57 offen offset:2048 sc1
    s_waitcnt vmcnt(14)
    v_mfma_f32_16x16x32_bf16 v[32:35], v[228:231], a[48:51], v[32:35]
    v_mfma_f32_16x16x32_bf16 v[36:39], v[228:231], a[52:55], v[36:39]
    v_mfma_f32_16x16x32_bf16 v[40:43], v[228:231], a[56:59], v[40:43]
    v_mfma_f32_16x16x32_bf16 v[44:47], v[228:231], a[60:63], v[44:47]
    s_add_u32 s57, s68, 6
    s_and_b32 s57, s57, 15
    s_mul_i32 s57, s57, 7168
    s_add_u32 s57, s57, s56
    buffer_load_dwordx4 v[200:203], v29, s[32:35], s57 offen offset:0 sc1
    v_mfma_f32_16x16x32_bf16 v[48:51], v[232:235], a[48:51], v[48:51]
    v_mfma_f32_16x16x32_bf16 v[52:55], v[232:235], a[52:55], v[52:55]
    v_mfma_f32_16x16x32_bf16 v[56:59], v[232:235], a[56:59], v[56:59]
    v_mfma_f32_16x16x32_bf16 v[60:63], v[232:235], a[60:63], v[60:63]
    buffer_load_dwordx4 v[204:207], v29, s[32:35], s57 offen offset:1024 sc1
    v_mfma_f32_16x16x32_bf16 v[64:67], v[236:239], a[48:51], v[64:67]
    v_mfma_f32_16x16x32_bf16 v[68:71], v[236:239], a[52:55], v[68:71]
    v_mfma_f32_16x16x32_bf16 v[72:75], v[236:239], a[56:59], v[72:75]
    v_mfma_f32_16x16x32_bf16 v[76:79], v[236:239], a[60:63], v[76:79]
    buffer_load_dwordx4 v[208:211], v29, s[32:35], s57 offen offset:2048 sc1
    v_mfma_f32_16x16x32_bf16 v[80:83], v[240:243], a[48:51], v[80:83]
    v_mfma_f32_16x16x32_bf16 v[84:87], v[240:243], a[52:55], v[84:87]
    v_mfma_f32_16x16x32_bf16 v[88:91], v[240:243], a[56:59], v[88:91]
    v_mfma_f32_16x16x32_bf16 v[92:95], v[240:243], a[60:63], v[92:95]
    buffer_load_dwordx4 v[212:215], v29, s[32:35], s57 offen offset:3072 sc1
    v_mfma_f32_16x16x32_bf16 v[96:99], v[244:247], a[48:51], v[96:99]
    v_mfma_f32_16x16x32_bf16 v[100:103], v[244:247], a[52:55], v[100:103]
    v_mfma_f32_16x16x32_bf16 v[104:107], v[244:247], a[56:59], v[104:107]
    v_mfma_f32_16x16x32_bf16 v[108:111], v[244:247], a[60:63], v[108:111]
    buffer_load_dwordx4 v[216:219], v30, s[32:35], s57 offen offset:0 sc1
    v_mfma_f32_16x16x32_bf16 v[112:115], v[248:251], a[48:51], v[112:115]
    v_mfma_f32_16x16x32_bf16 v[116:119], v[248:251], a[52:55], v[116:119]
    v_mfma_f32_16x16x32_bf16 v[120:123], v[248:251], a[56:59], v[120:123]
    v_mfma_f32_16x16x32_bf16 v[124:127], v[248:251], a[60:63], v[124:127]
    buffer_load_dwordx4 v[220:223], v30, s[32:35], s57 offen offset:1024 sc1
    v_mfma_f32_16x16x32_bf16 v[128:131], v[252:255], a[48:51], v[128:131]
    v_mfma_f32_16x16x32_bf16 v[132:135], v[252:255], a[52:55], v[132:135]
    v_mfma_f32_16x16x32_bf16 v[136:139], v[252:255], a[56:59], v[136:139]
    v_mfma_f32_16x16x32_bf16 v[140:143], v[252:255], a[60:63], v[140:143]
    buffer_load_dwordx4 v[224:227], v30, s[32:35], s57 offen offset:2048 sc1
    s_waitcnt vmcnt(14)
    v_mfma_f32_16x16x32_bf16 v[32:35], v[144:147], a[64:67], v[32:35]
    v_mfma_f32_16x16x32_bf16 v[36:39], v[144:147], a[68:71], v[36:39]
    v_mfma_f32_16x16x32_bf16 v[40:43], v[144:147], a[72:75], v[40:43]
    v_mfma_f32_16x16x32_bf16 v[44:47], v[144:147], a[76:79], v[44:47]
    s_add_u32 s57, s68, 7
    s_and_b32 s57, s57, 15
    s_mul_i32 s57, s57, 7168
    s_add_u32 s57, s57, s56
    buffer_load_dwordx4 v[228:231], v29, s[32:35], s57 offen offset:0 sc1
    v_mfma_f32_16x16x32_bf16 v[48:51], v[148:151], a[64:67], v[48:51]
    v_mfma_f32_16x16x32_bf16 v[52:55], v[148:151], a[68:71], v[52:55]
    v_mfma_f32_16x16x32_bf16 v[56:59], v[148:151], a[72:75], v[56:59]
    v_mfma_f32_16x16x32_bf16 v[60:63], v[148:151], a[76:79], v[60:63]
    buffer_load_dwordx4 v[232:235], v29, s[32:35], s57 offen offset:1024 sc1
    v_mfma_f32_16x16x32_bf16 v[64:67], v[152:155], a[64:67], v[64:67]
    v_mfma_f32_16x16x32_bf16 v[68:71], v[152:155], a[68:71], v[68:71]
    v_mfma_f32_16x16x32_bf16 v[72:75], v[152:155], a[72:75], v[72:75]
    v_mfma_f32_16x16x32_bf16 v[76:79], v[152:155], a[76:79], v[76:79]
    buffer_load_dwordx4 v[236:239], v29, s[32:35], s57 offen offset:2048 sc1
    v_mfma_f32_16x16x32_bf16 v[80:83], v[156:159], a[64:67], v[80:83]
    v_mfma_f32_16x16x32_bf16 v[84:87], v[156:159], a[68:71], v[84:87]
    v_mfma_f32_16x16x32_bf16 v[88:91], v[156:159], a[72:75], v[88:91]
    v_mfma_f32_16x16x32_bf16 v[92:95], v[156:159], a[76:79], v[92:95]
    buffer_load_dwordx4 v[240:243], v29, s[32:35], s57 offen offset:3072 sc1
    v_mfma_f32_16x16x32_bf16 v[96:99], v[160:163], a[64:67], v[96:99]
    v_mfma_f32_16x16x32_bf16 v[100:103], v[160:163], a[68:71], v[100:103]
    v_mfma_f32_16x16x32_bf16 v[104:107], v[160:163], a[72:75], v[104:107]
    v_mfma_f32_16x16x32_bf16 v[108:111], v[160:163], a[76:79], v[108:111]
    buffer_load_dwordx4 v[244:247], v30, s[32:35], s57 offen offset:0 sc1
    v_mfma_f32_16x16x32_bf16 v[112:115], v[164:167], a[64:67], v[112:115]
    v_mfma_f32_16x16x32_bf16 v[116:119], v[164:167], a[68:71], v[116:119]
    v_mfma_f32_16x16x32_bf16 v[120:123], v[164:167], a[72:75], v[120:123]
    v_mfma_f32_16x16x32_bf16 v[124:127], v[164:167], a[76:79], v[124:127]
    buffer_load_dwordx4 v[248:251], v30, s[32:35], s57 offen offset:1024 sc1
    v_mfma_f32_16x16x32_bf16 v[128:131], v[168:171], a[64:67], v[128:131]
    v_mfma_f32_16x16x32_bf16 v[132:135], v[168:171], a[68:71], v[132:135]
    v_mfma_f32_16x16x32_bf16 v[136:139], v[168:171], a[72:75], v[136:139]
    v_mfma_f32_16x16x32_bf16 v[140:143], v[168:171], a[76:79], v[140:143]
    buffer_load_dwordx4 v[252:255], v30, s[32:35], s57 offen offset:2048 sc1
    s_waitcnt vmcnt(14)
    v_mfma_f32_16x16x32_bf16 v[32:35], v[172:175], a[80:83], v[32:35]
    v_mfma_f32_16x16x32_bf16 v[36:39], v[172:175], a[84:87], v[36:39]
    v_mfma_f32_16x16x32_bf16 v[40:43], v[172:175], a[88:91], v[40:43]
    v_mfma_f32_16x16x32_bf16 v[44:47], v[172:175], a[92:95], v[44:47]
    s_add_u32 s57, s68, 8
    s_and_b32 s57, s57, 15
    s_mul_i32 s57, s57, 7168
    s_add_u32 s57, s57, s56
    buffer_load_dwordx4 v[144:147], v29, s[32:35], s57 offen offset:0 sc1
    v_mfma_f32_16x16x32_bf16 v[48:51], v[176:179], a[80:83], v[48:51]
    v_mfma_f32_16x16x32_bf16 v[52:55], v[176:179], a[84:87], v[52:55]
    v_mfma_f32_16x16x32_bf16 v[56:59], v[176:179], a[88:91], v[56:59]
    v_mfma_f32_16x16x32_bf16 v[60:63], v[176:179], a[92:95], v[60:63]
    buffer_load_dwordx4 v[148:151], v29, s[32:35], s57 offen offset:1024 sc1
    v_mfma_f32_16x16x32_bf16 v[64:67], v[180:183], a[80:83], v[64:67]
    v_mfma_f32_16x16x32_bf16 v[68:71], v[180:183], a[84:87], v[68:71]
    v_mfma_f32_16x16x32_bf16 v[72:75], v[180:183], a[88:91], v[72:75]
    v_mfma_f32_16x16x32_bf16 v[76:79], v[180:183], a[92:95], v[76:79]
    buffer_load_dwordx4 v[152:155], v29, s[32:35], s57 offen offset:2048 sc1
    v_mfma_f32_16x16x32_bf16 v[80:83], v[184:187], a[80:83], v[80:83]
    v_mfma_f32_16x16x32_bf16 v[84:87], v[184:187], a[84:87], v[84:87]
    v_mfma_f32_16x16x32_bf16 v[88:91], v[184:187], a[88:91], v[88:91]
    v_mfma_f32_16x16x32_bf16 v[92:95], v[184:187], a[92:95], v[92:95]
    buffer_load_dwordx4 v[156:159], v29, s[32:35], s57 offen offset:3072 sc1
    v_mfma_f32_16x16x32_bf16 v[96:99], v[188:191], a[80:83], v[96:99]
    v_mfma_f32_16x16x32_bf16 v[100:103], v[188:191], a[84:87], v[100:103]
    v_mfma_f32_16x16x32_bf16 v[104:107], v[188:191], a[88:91], v[104:107]
    v_mfma_f32_16x16x32_bf16 v[108:111], v[188:191], a[92:95], v[108:111]
    buffer_load_dwordx4 v[160:163], v30, s[32:35], s57 offen offset:0 sc1
    v_mfma_f32_16x16x32_bf16 v[112:115], v[192:195], a[80:83], v[112:115]
    v_mfma_f32_16x16x32_bf16 v[116:119], v[192:195], a[84:87], v[116:119]
    v_mfma_f32_16x16x32_bf16 v[120:123], v[192:195], a[88:91], v[120:123]
    v_mfma_f32_16x16x32_bf16 v[124:127], v[192:195], a[92:95], v[124:127]
    buffer_load_dwordx4 v[164:167], v30, s[32:35], s57 offen offset:1024 sc1
    v_mfma_f32_16x16x32_bf16 v[128:131], v[196:199], a[80:83], v[128:131]
    v_mfma_f32_16x16x32_bf16 v[132:135], v[196:199], a[84:87], v[132:135]
    v_mfma_f32_16x16x32_bf16 v[136:139], v[196:199], a[88:91], v[136:139]
    v_mfma_f32_16x16x32_bf16 v[140:143], v[196:199], a[92:95], v[140:143]
    buffer_load_dwordx4 v[168:171], v30, s[32:35], s57 offen offset:2048 sc1
    s_waitcnt vmcnt(14)
    v_mfma_f32_16x16x32_bf16 v[32:35], v[200:203], a[96:99], v[32:35]
    v_mfma_f32_16x16x32_bf16 v[36:39], v[200:203], a[100:103], v[36:39]
    v_mfma_f32_16x16x32_bf16 v[40:43], v[200:203], a[104:107], v[40:43]
    v_mfma_f32_16x16x32_bf16 v[44:47], v[200:203], a[108:111], v[44:47]
    s_add_u32 s57, s68, 9
    s_and_b32 s57, s57, 15
    s_mul_i32 s57, s57, 7168
    s_add_u32 s57, s57, s56
    buffer_load_dwordx4 v[172:175], v29, s[32:35], s57 offen offset:0 sc1
    v_mfma_f32_16x16x32_bf16 v[48:51], v[204:207], a[96:99], v[48:51]
    v_mfma_f32_16x16x32_bf16 v[52:55], v[204:207], a[100:103], v[52:55]
    v_mfma_f32_16x16x32_bf16 v[56:59], v[204:207], a[104:107], v[56:59]
    v_mfma_f32_16x16x32_bf16 v[60:63], v[204:207], a[108:111], v[60:63]
    buffer_load_dwordx4 v[176:179], v29, s[32:35], s57 offen offset:1024 sc1
    v_mfma_f32_16x16x32_bf16 v[64:67], v[208:211], a[96:99], v[64:67]
    v_mfma_f32_16x16x32_bf16 v[68:71], v[208:211], a[100:103], v[68:71]
    v_mfma_f32_16x16x32_bf16 v[72:75], v[208:211], a[104:107], v[72:75]
    v_mfma_f32_16x16x32_bf16 v[76:79], v[208:211], a[108:111], v[76:79]
    buffer_load_dwordx4 v[180:183], v29, s[32:35], s57 offen offset:2048 sc1
    v_mfma_f32_16x16x32_bf16 v[80:83], v[212:215], a[96:99], v[80:83]
    v_mfma_f32_16x16x32_bf16 v[84:87], v[212:215], a[100:103], v[84:87]
    v_mfma_f32_16x16x32_bf16 v[88:91], v[212:215], a[104:107], v[88:91]
    v_mfma_f32_16x16x32_bf16 v[92:95], v[212:215], a[108:111], v[92:95]
    buffer_load_dwordx4 v[184:187], v29, s[32:35], s57 offen offset:3072 sc1
    v_mfma_f32_16x16x32_bf16 v[96:99], v[216:219], a[96:99], v[96:99]
    v_mfma_f32_16x16x32_bf16 v[100:103], v[216:219], a[100:103], v[100:103]
    v_mfma_f32_16x16x32_bf16 v[104:107], v[216:219], a[104:107], v[104:107]
    v_mfma_f32_16x16x32_bf16 v[108:111], v[216:219], a[108:111], v[108:111]
    buffer_load_dwordx4 v[188:191], v30, s[32:35], s57 offen offset:0 sc1
    v_mfma_f32_16x16x32_bf16 v[112:115], v[220:223], a[96:99], v[112:115]
    v_mfma_f32_16x16x32_bf16 v[116:119], v[220:223], a[100:103], v[116:119]
    v_mfma_f32_16x16x32_bf16 v[120:123], v[220:223], a[104:107], v[120:123]
    v_mfma_f32_16x16x32_bf16 v[124:127], v[220:223], a[108:111], v[124:127]
    buffer_load_dwordx4 v[192:195], v30, s[32:35], s57 offen offset:1024 sc1
    v_mfma_f32_16x16x32_bf16 v[128:131], v[224:227], a[96:99], v[128:131]
    v_mfma_f32_16x16x32_bf16 v[132:135], v[224:227], a[100:103], v[132:135]
    v_mfma_f32_16x16x32_bf16 v[136:139], v[224:227], a[104:107], v[136:139]
    v_mfma_f32_16x16x32_bf16 v[140:143], v[224:227], a[108:111], v[140:143]
    buffer_load_dwordx4 v[196:199], v30, s[32:35], s57 offen offset:2048 sc1
    s_waitcnt vmcnt(14)
    v_mfma_f32_16x16x32_bf16 v[32:35], v[228:231], a[112:115], v[32:35]
    v_mfma_f32_16x16x32_bf16 v[36:39], v[228:231], a[116:119], v[36:39]
    v_mfma_f32_16x16x32_bf16 v[40:43], v[228:231], a[120:123], v[40:43]
    v_mfma_f32_16x16x32_bf16 v[44:47], v[228:231], a[124:127], v[44:47]
    s_add_u32 s57, s68, 10
    s_and_b32 s57, s57, 15
    s_mul_i32 s57, s57, 7168
    s_add_u32 s57, s57, s56
    buffer_load_dwordx4 v[200:203], v29, s[32:35], s57 offen offset:0 sc1
    v_mfma_f32_16x16x32_bf16 v[48:51], v[232:235], a[112:115], v[48:51]
    v_mfma_f32_16x16x32_bf16 v[52:55], v[232:235], a[116:119], v[52:55]
    v_mfma_f32_16x16x32_bf16 v[56:59], v[232:235], a[120:123], v[56:59]
    v_mfma_f32_16x16x32_bf16 v[60:63], v[232:235], a[124:127], v[60:63]
    buffer_load_dwordx4 v[204:207], v29, s[32:35], s57 offen offset:1024 sc1
    v_mfma_f32_16x16x32_bf16 v[64:67], v[236:239], a[112:115], v[64:67]
    v_mfma_f32_16x16x32_bf16 v[68:71], v[236:239], a[116:119], v[68:71]
    v_mfma_f32_16x16x32_bf16 v[72:75], v[236:239], a[120:123], v[72:75]
    v_mfma_f32_16x16x32_bf16 v[76:79], v[236:239], a[124:127], v[76:79]
    buffer_load_dwordx4 v[208:211], v29, s[32:35], s57 offen offset:2048 sc1
    v_mfma_f32_16x16x32_bf16 v[80:83], v[240:243], a[112:115], v[80:83]
    v_mfma_f32_16x16x32_bf16 v[84:87], v[240:243], a[116:119], v[84:87]
    v_mfma_f32_16x16x32_bf16 v[88:91], v[240:243], a[120:123], v[88:91]
    v_mfma_f32_16x16x32_bf16 v[92:95], v[240:243], a[124:127], v[92:95]
    buffer_load_dwordx4 v[212:215], v29, s[32:35], s57 offen offset:3072 sc1
    v_mfma_f32_16x16x32_bf16 v[96:99], v[244:247], a[112:115], v[96:99]
    v_mfma_f32_16x16x32_bf16 v[100:103], v[244:247], a[116:119], v[100:103]
    v_mfma_f32_16x16x32_bf16 v[104:107], v[244:247], a[120:123], v[104:107]
    v_mfma_f32_16x16x32_bf16 v[108:111], v[244:247], a[124:127], v[108:111]
    buffer_load_dwordx4 v[216:219], v30, s[32:35], s57 offen offset:0 sc1
    v_mfma_f32_16x16x32_bf16 v[112:115], v[248:251], a[112:115], v[112:115]
    v_mfma_f32_16x16x32_bf16 v[116:119], v[248:251], a[116:119], v[116:119]
    v_mfma_f32_16x16x32_bf16 v[120:123], v[248:251], a[120:123], v[120:123]
    v_mfma_f32_16x16x32_bf16 v[124:127], v[248:251], a[124:127], v[124:127]
    buffer_load_dwordx4 v[220:223], v30, s[32:35], s57 offen offset:1024 sc1
    v_mfma_f32_16x16x32_bf16 v[128:131], v[252:255], a[112:115], v[128:131]
    v_mfma_f32_16x16x32_bf16 v[132:135], v[252:255], a[116:119], v[132:135]
    v_mfma_f32_16x16x32_bf16 v[136:139], v[252:255], a[120:123], v[136:139]
    v_mfma_f32_16x16x32_bf16 v[140:143], v[252:255], a[124:127], v[140:143]
    buffer_load_dwordx4 v[224:227], v30, s[32:35], s57 offen offset:2048 sc1
    s_waitcnt vmcnt(14)
    v_mfma_f32_16x16x32_bf16 v[32:35], v[144:147], a[128:131], v[32:35]
    v_mfma_f32_16x16x32_bf16 v[36:39], v[144:147], a[132:135], v[36:39]
    v_mfma_f32_16x16x32_bf16 v[40:43], v[144:147], a[136:139], v[40:43]
    v_mfma_f32_16x16x32_bf16 v[44:47], v[144:147], a[140:143], v[44:47]
    s_add_u32 s57, s68, 11
    s_and_b32 s57, s57, 15
    s_mul_i32 s57, s57, 7168
    s_add_u32 s57, s57, s56
    buffer_load_dwordx4 v[228:231], v29, s[32:35], s57 offen offset:0 sc1
    v_mfma_f32_16x16x32_bf16 v[48:51], v[148:151], a[128:131], v[48:51]
    v_mfma_f32_16x16x32_bf16 v[52:55], v[148:151], a[132:135], v[52:55]
    v_mfma_f32_16x16x32_bf16 v[56:59], v[148:151], a[136:139], v[56:59]
    v_mfma_f32_16x16x32_bf16 v[60:63], v[148:151], a[140:143], v[60:63]
    buffer_load_dwordx4 v[232:235], v29, s[32:35], s57 offen offset:1024 sc1
    v_mfma_f32_16x16x32_bf16 v[64:67], v[152:155], a[128:131], v[64:67]
    v_mfma_f32_16x16x32_bf16 v[68:71], v[152:155], a[132:135], v[68:71]
    v_mfma_f32_16x16x32_bf16 v[72:75], v[152:155], a[136:139], v[72:75]
    v_mfma_f32_16x16x32_bf16 v[76:79], v[152:155], a[140:143], v[76:79]
    buffer_load_dwordx4 v[236:239], v29, s[32:35], s57 offen offset:2048 sc1
    v_mfma_f32_16x16x32_bf16 v[80:83], v[156:159], a[128:131], v[80:83]
    v_mfma_f32_16x16x32_bf16 v[84:87], v[156:159], a[132:135], v[84:87]
    v_mfma_f32_16x16x32_bf16 v[88:91], v[156:159], a[136:139], v[88:91]
    v_mfma_f32_16x16x32_bf16 v[92:95], v[156:159], a[140:143], v[92:95]
    buffer_load_dwordx4 v[240:243], v29, s[32:35], s57 offen offset:3072 sc1
    v_mfma_f32_16x16x32_bf16 v[96:99], v[160:163], a[128:131], v[96:99]
    v_mfma_f32_16x16x32_bf16 v[100:103], v[160:163], a[132:135], v[100:103]
    v_mfma_f32_16x16x32_bf16 v[104:107], v[160:163], a[136:139], v[104:107]
    v_mfma_f32_16x16x32_bf16 v[108:111], v[160:163], a[140:143], v[108:111]
    buffer_load_dwordx4 v[244:247], v30, s[32:35], s57 offen offset:0 sc1
    v_mfma_f32_16x16x32_bf16 v[112:115], v[164:167], a[128:131], v[112:115]
    v_mfma_f32_16x16x32_bf16 v[116:119], v[164:167], a[132:135], v[116:119]
    v_mfma_f32_16x16x32_bf16 v[120:123], v[164:167], a[136:139], v[120:123]
    v_mfma_f32_16x16x32_bf16 v[124:127], v[164:167], a[140:143], v[124:127]
    buffer_load_dwordx4 v[248:251], v30, s[32:35], s57 offen offset:1024 sc1
    v_mfma_f32_16x16x32_bf16 v[128:131], v[168:171], a[128:131], v[128:131]
    v_mfma_f32_16x16x32_bf16 v[132:135], v[168:171], a[132:135], v[132:135]
    v_mfma_f32_16x16x32_bf16 v[136:139], v[168:171], a[136:139], v[136:139]
    v_mfma_f32_16x16x32_bf16 v[140:143], v[168:171], a[140:143], v[140:143]
    buffer_load_dwordx4 v[252:255], v30, s[32:35], s57 offen offset:2048 sc1
    s_waitcnt vmcnt(14)
    v_mfma_f32_16x16x32_bf16 v[32:35], v[172:175], a[144:147], v[32:35]
    v_mfma_f32_16x16x32_bf16 v[36:39], v[172:175], a[148:151], v[36:39]
    v_mfma_f32_16x16x32_bf16 v[40:43], v[172:175], a[152:155], v[40:43]
    v_mfma_f32_16x16x32_bf16 v[44:47], v[172:175], a[156:159], v[44:47]
    s_add_u32 s57, s68, 12
    s_and_b32 s57, s57, 15
    s_mul_i32 s57, s57, 7168
    s_add_u32 s57, s57, s56
    buffer_load_dwordx4 v[144:147], v29, s[32:35], s57 offen offset:0 sc1
    v_mfma_f32_16x16x32_bf16 v[48:51], v[176:179], a[144:147], v[48:51]
    v_mfma_f32_16x16x32_bf16 v[52:55], v[176:179], a[148:151], v[52:55]
    v_mfma_f32_16x16x32_bf16 v[56:59], v[176:179], a[152:155], v[56:59]
    v_mfma_f32_16x16x32_bf16 v[60:63], v[176:179], a[156:159], v[60:63]
    buffer_load_dwordx4 v[148:151], v29, s[32:35], s57 offen offset:1024 sc1
    v_mfma_f32_16x16x32_bf16 v[64:67], v[180:183], a[144:147], v[64:67]
    v_mfma_f32_16x16x32_bf16 v[68:71], v[180:183], a[148:151], v[68:71]
    v_mfma_f32_16x16x32_bf16 v[72:75], v[180:183], a[152:155], v[72:75]
    v_mfma_f32_16x16x32_bf16 v[76:79], v[180:183], a[156:159], v[76:79]
    buffer_load_dwordx4 v[152:155], v29, s[32:35], s57 offen offset:2048 sc1
    v_mfma_f32_16x16x32_bf16 v[80:83], v[184:187], a[144:147], v[80:83]
    v_mfma_f32_16x16x32_bf16 v[84:87], v[184:187], a[148:151], v[84:87]
    v_mfma_f32_16x16x32_bf16 v[88:91], v[184:187], a[152:155], v[88:91]
    v_mfma_f32_16x16x32_bf16 v[92:95], v[184:187], a[156:159], v[92:95]
    buffer_load_dwordx4 v[156:159], v29, s[32:35], s57 offen offset:3072 sc1
    v_mfma_f32_16x16x32_bf16 v[96:99], v[188:191], a[144:147], v[96:99]
    v_mfma_f32_16x16x32_bf16 v[100:103], v[188:191], a[148:151], v[100:103]
    v_mfma_f32_16x16x32_bf16 v[104:107], v[188:191], a[152:155], v[104:107]
    v_mfma_f32_16x16x32_bf16 v[108:111], v[188:191], a[156:159], v[108:111]
    buffer_load_dwordx4 v[160:163], v30, s[32:35], s57 offen offset:0 sc1
    v_mfma_f32_16x16x32_bf16 v[112:115], v[192:195], a[144:147], v[112:115]
    v_mfma_f32_16x16x32_bf16 v[116:119], v[192:195], a[148:151], v[116:119]
    v_mfma_f32_16x16x32_bf16 v[120:123], v[192:195], a[152:155], v[120:123]
    v_mfma_f32_16x16x32_bf16 v[124:127], v[192:195], a[156:159], v[124:127]
    buffer_load_dwordx4 v[164:167], v30, s[32:35], s57 offen offset:1024 sc1
    v_mfma_f32_16x16x32_bf16 v[128:131], v[196:199], a[144:147], v[128:131]
    v_mfma_f32_16x16x32_bf16 v[132:135], v[196:199], a[148:151], v[132:135]
    v_mfma_f32_16x16x32_bf16 v[136:139], v[196:199], a[152:155], v[136:139]
    v_mfma_f32_16x16x32_bf16 v[140:143], v[196:199], a[156:159], v[140:143]
    buffer_load_dwordx4 v[168:171], v30, s[32:35], s57 offen offset:2048 sc1
    s_waitcnt vmcnt(14)
    v_mfma_f32_16x16x32_bf16 v[32:35], v[200:203], a[160:163], v[32:35]
    v_mfma_f32_16x16x32_bf16 v[36:39], v[200:203], a[164:167], v[36:39]
    v_mfma_f32_16x16x32_bf16 v[40:43], v[200:203], a[168:171], v[40:43]
    v_mfma_f32_16x16x32_bf16 v[44:47], v[200:203], a[172:175], v[44:47]
    s_add_u32 s57, s68, 13
    s_and_b32 s57, s57, 15
    s_mul_i32 s57, s57, 7168
    s_add_u32 s57, s57, s56
    buffer_load_dwordx4 v[172:175], v29, s[32:35], s57 offen offset:0 sc1
    v_mfma_f32_16x16x32_bf16 v[48:51], v[204:207], a[160:163], v[48:51]
    v_mfma_f32_16x16x32_bf16 v[52:55], v[204:207], a[164:167], v[52:55]
    v_mfma_f32_16x16x32_bf16 v[56:59], v[204:207], a[168:171], v[56:59]
    v_mfma_f32_16x16x32_bf16 v[60:63], v[204:207], a[172:175], v[60:63]
    buffer_load_dwordx4 v[176:179], v29, s[32:35], s57 offen offset:1024 sc1
    v_mfma_f32_16x16x32_bf16 v[64:67], v[208:211], a[160:163], v[64:67]
    v_mfma_f32_16x16x32_bf16 v[68:71], v[208:211], a[164:167], v[68:71]
    v_mfma_f32_16x16x32_bf16 v[72:75], v[208:211], a[168:171], v[72:75]
    v_mfma_f32_16x16x32_bf16 v[76:79], v[208:211], a[172:175], v[76:79]
    buffer_load_dwordx4 v[180:183], v29, s[32:35], s57 offen offset:2048 sc1
    v_mfma_f32_16x16x32_bf16 v[80:83], v[212:215], a[160:163], v[80:83]
    v_mfma_f32_16x16x32_bf16 v[84:87], v[212:215], a[164:167], v[84:87]
    v_mfma_f32_16x16x32_bf16 v[88:91], v[212:215], a[168:171], v[88:91]
    v_mfma_f32_16x16x32_bf16 v[92:95], v[212:215], a[172:175], v[92:95]
    buffer_load_dwordx4 v[184:187], v29, s[32:35], s57 offen offset:3072 sc1
    v_mfma_f32_16x16x32_bf16 v[96:99], v[216:219], a[160:163], v[96:99]
    v_mfma_f32_16x16x32_bf16 v[100:103], v[216:219], a[164:167], v[100:103]
    v_mfma_f32_16x16x32_bf16 v[104:107], v[216:219], a[168:171], v[104:107]
    v_mfma_f32_16x16x32_bf16 v[108:111], v[216:219], a[172:175], v[108:111]
    buffer_load_dwordx4 v[188:191], v30, s[32:35], s57 offen offset:0 sc1
    v_mfma_f32_16x16x32_bf16 v[112:115], v[220:223], a[160:163], v[112:115]
    v_mfma_f32_16x16x32_bf16 v[116:119], v[220:223], a[164:167], v[116:119]
    v_mfma_f32_16x16x32_bf16 v[120:123], v[220:223], a[168:171], v[120:123]
    v_mfma_f32_16x16x32_bf16 v[124:127], v[220:223], a[172:175], v[124:127]
    buffer_load_dwordx4 v[192:195], v30, s[32:35], s57 offen offset:1024 sc1
    v_mfma_f32_16x16x32_bf16 v[128:131], v[224:227], a[160:163], v[128:131]
    v_mfma_f32_16x16x32_bf16 v[132:135], v[224:227], a[164:167], v[132:135]
    v_mfma_f32_16x16x32_bf16 v[136:139], v[224:227], a[168:171], v[136:139]
    v_mfma_f32_16x16x32_bf16 v[140:143], v[224:227], a[172:175], v[140:143]
    buffer_load_dwordx4 v[196:199], v30, s[32:35], s57 offen offset:2048 sc1
    s_waitcnt vmcnt(14)
    v_mfma_f32_16x16x32_bf16 v[32:35], v[228:231], a[176:179], v[32:35]
    v_mfma_f32_16x16x32_bf16 v[36:39], v[228:231], a[180:183], v[36:39]
    v_mfma_f32_16x16x32_bf16 v[40:43], v[228:231], a[184:187], v[40:43]
    v_mfma_f32_16x16x32_bf16 v[44:47], v[228:231], a[188:191], v[44:47]
    s_add_u32 s57, s68, 14
    s_and_b32 s57, s57, 15
    s_mul_i32 s57, s57, 7168
    s_add_u32 s57, s57, s56
    buffer_load_dwordx4 v[200:203], v29, s[32:35], s57 offen offset:0 sc1
    v_mfma_f32_16x16x32_bf16 v[48:51], v[232:235], a[176:179], v[48:51]
    v_mfma_f32_16x16x32_bf16 v[52:55], v[232:235], a[180:183], v[52:55]
    v_mfma_f32_16x16x32_bf16 v[56:59], v[232:235], a[184:187], v[56:59]
    v_mfma_f32_16x16x32_bf16 v[60:63], v[232:235], a[188:191], v[60:63]
    buffer_load_dwordx4 v[204:207], v29, s[32:35], s57 offen offset:1024 sc1
    v_mfma_f32_16x16x32_bf16 v[64:67], v[236:239], a[176:179], v[64:67]
    v_mfma_f32_16x16x32_bf16 v[68:71], v[236:239], a[180:183], v[68:71]
    v_mfma_f32_16x16x32_bf16 v[72:75], v[236:239], a[184:187], v[72:75]
    v_mfma_f32_16x16x32_bf16 v[76:79], v[236:239], a[188:191], v[76:79]
    buffer_load_dwordx4 v[208:211], v29, s[32:35], s57 offen offset:2048 sc1
    v_mfma_f32_16x16x32_bf16 v[80:83], v[240:243], a[176:179], v[80:83]
    v_mfma_f32_16x16x32_bf16 v[84:87], v[240:243], a[180:183], v[84:87]
    v_mfma_f32_16x16x32_bf16 v[88:91], v[240:243], a[184:187], v[88:91]
    v_mfma_f32_16x16x32_bf16 v[92:95], v[240:243], a[188:191], v[92:95]
    buffer_load_dwordx4 v[212:215], v29, s[32:35], s57 offen offset:3072 sc1
    v_mfma_f32_16x16x32_bf16 v[96:99], v[244:247], a[176:179], v[96:99]
    v_mfma_f32_16x16x32_bf16 v[100:103], v[244:247], a[180:183], v[100:103]
    v_mfma_f32_16x16x32_bf16 v[104:107], v[244:247], a[184:187], v[104:107]
    v_mfma_f32_16x16x32_bf16 v[108:111], v[244:247], a[188:191], v[108:111]
    buffer_load_dwordx4 v[216:219], v30, s[32:35], s57 offen offset:0 sc1
    v_mfma_f32_16x16x32_bf16 v[112:115], v[248:251], a[176:179], v[112:115]
    v_mfma_f32_16x16x32_bf16 v[116:119], v[248:251], a[180:183], v[116:119]
    v_mfma_f32_16x16x32_bf16 v[120:123], v[248:251], a[184:187], v[120:123]
    v_mfma_f32_16x16x32_bf16 v[124:127], v[248:251], a[188:191], v[124:127]
    buffer_load_dwordx4 v[220:223], v30, s[32:35], s57 offen offset:1024 sc1
    v_mfma_f32_16x16x32_bf16 v[128:131], v[252:255], a[176:179], v[128:131]
    v_mfma_f32_16x16x32_bf16 v[132:135], v[252:255], a[180:183], v[132:135]
    v_mfma_f32_16x16x32_bf16 v[136:139], v[252:255], a[184:187], v[136:139]
    v_mfma_f32_16x16x32_bf16 v[140:143], v[252:255], a[188:191], v[140:143]
    buffer_load_dwordx4 v[224:227], v30, s[32:35], s57 offen offset:2048 sc1
    s_waitcnt vmcnt(14)
    s_waitcnt lgkmcnt(0)
    v_mfma_f32_16x16x32_bf16 v[32:35], v[144:147], a[192:195], v[32:35]
    v_mfma_f32_16x16x32_bf16 v[36:39], v[144:147], a[196:199], v[36:39]
    v_mfma_f32_16x16x32_bf16 v[40:43], v[144:147], a[200:203], v[40:43]
    v_mfma_f32_16x16x32_bf16 v[44:47], v[144:147], a[204:207], v[44:47]
    s_add_u32 s57, s68, 15
    s_and_b32 s57, s57, 15
    s_mul_i32 s57, s57, 7168
    s_add_u32 s57, s57, s56
    buffer_load_dwordx4 v[228:231], v29, s[32:35], s57 offen offset:0 sc1
    v_mfma_f32_16x16x32_bf16 v[48:51], v[148:151], a[192:195], v[48:51]
    v_mfma_f32_16x16x32_bf16 v[52:55], v[148:151], a[196:199], v[52:55]
    v_mfma_f32_16x16x32_bf16 v[56:59], v[148:151], a[200:203], v[56:59]
    v_mfma_f32_16x16x32_bf16 v[60:63], v[148:151], a[204:207], v[60:63]
    buffer_load_dwordx4 v[232:235], v29, s[32:35], s57 offen offset:1024 sc1
    v_mfma_f32_16x16x32_bf16 v[64:67], v[152:155], a[192:195], v[64:67]
    v_mfma_f32_16x16x32_bf16 v[68:71], v[152:155], a[196:199], v[68:71]
    v_mfma_f32_16x16x32_bf16 v[72:75], v[152:155], a[200:203], v[72:75]
    v_mfma_f32_16x16x32_bf16 v[76:79], v[152:155], a[204:207], v[76:79]
    buffer_load_dwordx4 v[236:239], v29, s[32:35], s57 offen offset:2048 sc1
    v_mfma_f32_16x16x32_bf16 v[80:83], v[156:159], a[192:195], v[80:83]
    v_mfma_f32_16x16x32_bf16 v[84:87], v[156:159], a[196:199], v[84:87]
    v_mfma_f32_16x16x32_bf16 v[88:91], v[156:159], a[200:203], v[88:91]
    v_mfma_f32_16x16x32_bf16 v[92:95], v[156:159], a[204:207], v[92:95]
    buffer_load_dwordx4 v[240:243], v29, s[32:35], s57 offen offset:3072 sc1
    v_mfma_f32_16x16x32_bf16 v[96:99], v[160:163], a[192:195], v[96:99]
    v_mfma_f32_16x16x32_bf16 v[100:103], v[160:163], a[196:199], v[100:103]
    v_mfma_f32_16x16x32_bf16 v[104:107], v[160:163], a[200:203], v[104:107]
    v_mfma_f32_16x16x32_bf16 v[108:111], v[160:163], a[204:207], v[108:111]
    buffer_load_dwordx4 v[244:247], v30, s[32:35], s57 offen offset:0 sc1
    v_mfma_f32_16x16x32_bf16 v[112:115], v[164:167], a[192:195], v[112:115]
    v_mfma_f32_16x16x32_bf16 v[116:119], v[164:167], a[196:199], v[116:119]
    v_mfma_f32_16x16x32_bf16 v[120:123], v[164:167], a[200:203], v[120:123]
    v_mfma_f32_16x16x32_bf16 v[124:127], v[164:167], a[204:207], v[124:127]
    buffer_load_dwordx4 v[248:251], v30, s[32:35], s57 offen offset:1024 sc1
    v_mfma_f32_16x16x32_bf16 v[128:131], v[168:171], a[192:195], v[128:131]
    v_mfma_f32_16x16x32_bf16 v[132:135], v[168:171], a[196:199], v[132:135]
    v_mfma_f32_16x16x32_bf16 v[136:139], v[168:171], a[200:203], v[136:139]
    v_mfma_f32_16x16x32_bf16 v[140:143], v[168:171], a[204:207], v[140:143]
    buffer_load_dwordx4 v[252:255], v30, s[32:35], s57 offen offset:2048 sc1
    s_waitcnt vmcnt(14)
    v_mfma_f32_16x16x32_bf16 v[32:35], v[172:175], a[208:211], v[32:35]
    v_mfma_f32_16x16x32_bf16 v[36:39], v[172:175], a[212:215], v[36:39]
    v_mfma_f32_16x16x32_bf16 v[40:43], v[172:175], a[216:219], v[40:43]
    v_mfma_f32_16x16x32_bf16 v[44:47], v[172:175], a[220:223], v[44:47]
    s_add_u32 s66, s58, 0
    buffer_load_dwordx4 a[0:3], v31, s[32:35], s66 offen offset:0 sc1
    v_mfma_f32_16x16x32_bf16 v[48:51], v[176:179], a[208:211], v[48:51]
    v_mfma_f32_16x16x32_bf16 v[52:55], v[176:179], a[212:215], v[52:55]
    v_mfma_f32_16x16x32_bf16 v[56:59], v[176:179], a[216:219], v[56:59]
    v_mfma_f32_16x16x32_bf16 v[60:63], v[176:179], a[220:223], v[60:63]
    s_add_u32 s66, s58, 28672
    buffer_load_dwordx4 a[4:7], v31, s[32:35], s66 offen offset:0 sc1
    v_mfma_f32_16x16x32_bf16 v[64:67], v[180:183], a[208:211], v[64:67]
    v_mfma_f32_16x16x32_bf16 v[68:71], v[180:183], a[212:215], v[68:71]
    v_mfma_f32_16x16x32_bf16 v[72:75], v[180:183], a[216:219], v[72:75]
    v_mfma_f32_16x16x32_bf16 v[76:79], v[180:183], a[220:223], v[76:79]
    s_add_u32 s66, s58, 1024
    buffer_load_dwordx4 a[8:11], v31, s[32:35], s66 offen offset:0 sc1
    v_mfma_f32_16x16x32_bf16 v[80:83], v[184:187], a[208:211], v[80:83]
    v_mfma_f32_16x16x32_bf16 v[84:87], v[184:187], a[212:215], v[84:87]
    v_mfma_f32_16x16x32_bf16 v[88:91], v[184:187], a[216:219], v[88:91]
    v_mfma_f32_16x16x32_bf16 v[92:95], v[184:187], a[220:223], v[92:95]
    s_add_u32 s66, s58, 29696
    buffer_load_dwordx4 a[12:15], v31, s[32:35], s66 offen offset:0 sc1
    v_mfma_f32_16x16x32_bf16 v[96:99], v[188:191], a[208:211], v[96:99]
    v_mfma_f32_16x16x32_bf16 v[100:103], v[188:191], a[212:215], v[100:103]
    v_mfma_f32_16x16x32_bf16 v[104:107], v[188:191], a[216:219], v[104:107]
    v_mfma_f32_16x16x32_bf16 v[108:111], v[188:191], a[220:223], v[108:111]
    s_add_u32 s66, s58, 2048
    buffer_load_dwordx4 a[16:19], v31, s[32:35], s66 offen offset:0 sc1
    v_mfma_f32_16x16x32_bf16 v[112:115], v[192:195], a[208:211], v[112:115]
    v_mfma_f32_16x16x32_bf16 v[116:119], v[192:195], a[212:215], v[116:119]
    v_mfma_f32_16x16x32_bf16 v[120:123], v[192:195], a[216:219], v[120:123]
    v_mfma_f32_16x16x32_bf16 v[124:127], v[192:195], a[220:223], v[124:127]
    s_add_u32 s66, s58, 30720
    buffer_load_dwordx4 a[20:23], v31, s[32:35], s66 offen offset:0 sc1
    v_mfma_f32_16x16x32_bf16 v[128:131], v[196:199], a[208:211], v[128:131]
    v_mfma_f32_16x16x32_bf16 v[132:135], v[196:199], a[212:215], v[132:135]
    v_mfma_f32_16x16x32_bf16 v[136:139], v[196:199], a[216:219], v[136:139]
    v_mfma_f32_16x16x32_bf16 v[140:143], v[196:199], a[220:223], v[140:143]
    s_add_u32 s66, s58, 3072
    buffer_load_dwordx4 a[24:27], v31, s[32:35], s66 offen offset:0 sc1
    s_waitcnt vmcnt(14)
    v_mfma_f32_16x16x32_bf16 v[32:35], v[200:203], a[224:227], v[32:35]
    v_mfma_f32_16x16x32_bf16 v[36:39], v[200:203], a[228:231], v[36:39]
    v_mfma_f32_16x16x32_bf16 v[40:43], v[200:203], a[232:235], v[40:43]
    v_mfma_f32_16x16x32_bf16 v[44:47], v[200:203], a[236:239], v[44:47]
    s_add_u32 s66, s58, 31744
    buffer_load_dwordx4 a[28:31], v31, s[32:35], s66 offen offset:0 sc1
    v_mfma_f32_16x16x32_bf16 v[48:51], v[204:207], a[224:227], v[48:51]
    v_mfma_f32_16x16x32_bf16 v[52:55], v[204:207], a[228:231], v[52:55]
    v_mfma_f32_16x16x32_bf16 v[56:59], v[204:207], a[232:235], v[56:59]
    v_mfma_f32_16x16x32_bf16 v[60:63], v[204:207], a[236:239], v[60:63]
    s_add_u32 s66, s58, 4096
    buffer_load_dwordx4 a[32:35], v31, s[32:35], s66 offen offset:0 sc1
    v_mfma_f32_16x16x32_bf16 v[64:67], v[208:211], a[224:227], v[64:67]
    v_mfma_f32_16x16x32_bf16 v[68:71], v[208:211], a[228:231], v[68:71]
    v_mfma_f32_16x16x32_bf16 v[72:75], v[208:211], a[232:235], v[72:75]
    v_mfma_f32_16x16x32_bf16 v[76:79], v[208:211], a[236:239], v[76:79]
    s_add_u32 s66, s58, 32768
    buffer_load_dwordx4 a[36:39], v31, s[32:35], s66 offen offset:0 sc1
    v_mfma_f32_16x16x32_bf16 v[80:83], v[212:215], a[224:227], v[80:83]
    v_mfma_f32_16x16x32_bf16 v[84:87], v[212:215], a[228:231], v[84:87]
    v_mfma_f32_16x16x32_bf16 v[88:91], v[212:215], a[232:235], v[88:91]
    v_mfma_f32_16x16x32_bf16 v[92:95], v[212:215], a[236:239], v[92:95]
    s_add_u32 s66, s58, 5120
    buffer_load_dwordx4 a[40:43], v31, s[32:35], s66 offen offset:0 sc1
    v_mfma_f32_16x16x32_bf16 v[96:99], v[216:219], a[224:227], v[96:99]
    v_mfma_f32_16x16x32_bf16 v[100:103], v[216:219], a[228:231], v[100:103]
    v_mfma_f32_16x16x32_bf16 v[104:107], v[216:219], a[232:235], v[104:107]
    v_mfma_f32_16x16x32_bf16 v[108:111], v[216:219], a[236:239], v[108:111]
    s_add_u32 s66, s58, 33792
    buffer_load_dwordx4 a[44:47], v31, s[32:35], s66 offen offset:0 sc1
    v_mfma_f32_16x16x32_bf16 v[112:115], v[220:223], a[224:227], v[112:115]
    v_mfma_f32_16x16x32_bf16 v[116:119], v[220:223], a[228:231], v[116:119]
    v_mfma_f32_16x16x32_bf16 v[120:123], v[220:223], a[232:235], v[120:123]
    v_mfma_f32_16x16x32_bf16 v[124:127], v[220:223], a[236:239], v[124:127]
    s_add_u32 s66, s58, 6144
    buffer_load_dwordx4 a[48:51], v31, s[32:35], s66 offen offset:0 sc1
    v_mfma_f32_16x16x32_bf16 v[128:131], v[224:227], a[224:227], v[128:131]
    v_mfma_f32_16x16x32_bf16 v[132:135], v[224:227], a[228:231], v[132:135]
    v_mfma_f32_16x16x32_bf16 v[136:139], v[224:227], a[232:235], v[136:139]
    v_mfma_f32_16x16x32_bf16 v[140:143], v[224:227], a[236:239], v[140:143]
    s_add_u32 s66, s58, 34816
    buffer_load_dwordx4 a[52:55], v31, s[32:35], s66 offen offset:0 sc1
    s_waitcnt vmcnt(14)
    v_mfma_f32_16x16x32_bf16 v[36:39], v[228:231], a[244:247], v[36:39]
    v_mfma_f32_16x16x32_bf16 v[52:55], v[232:235], a[244:247], v[52:55]
    v_mfma_f32_16x16x32_bf16 v[68:71], v[236:239], a[244:247], v[68:71]
    v_mfma_f32_16x16x32_bf16 v[84:87], v[240:243], a[244:247], v[84:87]
    s_add_u32 s66, s58, 7168
    buffer_load_dwordx4 a[56:59], v31, s[32:35], s66 offen offset:0 sc1
    v_mfma_f32_16x16x32_bf16 v[100:103], v[244:247], a[244:247], v[100:103]
    v_mfma_f32_16x16x32_bf16 v[116:119], v[248:251], a[244:247], v[116:119]
    v_mfma_f32_16x16x32_bf16 v[132:135], v[252:255], a[244:247], v[132:135]
    v_mfma_f32_16x16x32_bf16 v[40:43], v[228:231], a[248:251], v[40:43]
    s_add_u32 s66, s58, 35840
    buffer_load_dwordx4 a[60:63], v31, s[32:35], s66 offen offset:0 sc1
    v_mfma_f32_16x16x32_bf16 v[56:59], v[232:235], a[248:251], v[56:59]
    ds_write_b128 v2, v[36:39] offset:0
    v_mfma_f32_16x16x32_bf16 v[72:75], v[236:239], a[248:251], v[72:75]
    ds_write_b128 v2, v[52:55] offset:1024
    v_mfma_f32_16x16x32_bf16 v[88:91], v[240:243], a[248:251], v[88:91]
    ds_write_b128 v2, v[68:71] offset:2048
    v_mfma_f32_16x16x32_bf16 v[104:107], v[244:247], a[248:251], v[104:107]
    s_add_u32 s66, s58, 8192
    buffer_load_dwordx4 a[64:67], v31, s[32:35], s66 offen offset:0 sc1
    ds_write_b128 v2, v[84:87] offset:3072
    v_mfma_f32_16x16x32_bf16 v[120:123], v[248:251], a[248:251], v[120:123]
    ds_write_b128 v2, v[100:103] offset:4096
    v_mfma_f32_16x16x32_bf16 v[136:139], v[252:255], a[248:251], v[136:139]
    ds_write_b128 v2, v[116:119] offset:5120
    v_mfma_f32_16x16x32_bf16 v[44:47], v[228:231], a[252:255], v[44:47]
    ds_write_b128 v2, v[132:135] offset:6144
    v_mfma_f32_16x16x32_bf16 v[60:63], v[232:235], a[252:255], v[60:63]
    s_add_u32 s66, s58, 36864
    buffer_load_dwordx4 a[68:71], v31, s[32:35], s66 offen offset:0 sc1
    ds_write_b128 v2, v[40:43] offset:7168
    v_mfma_f32_16x16x32_bf16 v[76:79], v[236:239], a[252:255], v[76:79]
    ds_write_b128 v2, v[56:59] offset:8192
    v_mfma_f32_16x16x32_bf16 v[92:95], v[240:243], a[252:255], v[92:95]
    ds_write_b128 v2, v[72:75] offset:9216
    v_mfma_f32_16x16x32_bf16 v[108:111], v[244:247], a[252:255], v[108:111]
    ds_write_b128 v2, v[88:91] offset:10240
    v_mfma_f32_16x16x32_bf16 v[124:127], v[248:251], a[252:255], v[124:127]
    s_add_u32 s66, s58, 9216
    buffer_load_dwordx4 a[72:75], v31, s[32:35], s66 offen offset:0 sc1
    ds_write_b128 v2, v[104:107] offset:11264
    v_mfma_f32_16x16x32_bf16 v[140:143], v[252:255], a[252:255], v[140:143]
    ds_write_b128 v2, v[120:123] offset:12288
    v_mfma_f32_16x16x32_bf16 v[32:35], v[228:231], a[240:243], v[32:35]
    ds_write_b128 v2, v[136:139] offset:13312
    v_mfma_f32_16x16x32_bf16 v[48:51], v[232:235], a[240:243], v[48:51]
    ds_write_b128 v2, v[44:47] offset:14336
    v_mfma_f32_16x16x32_bf16 v[64:67], v[236:239], a[240:243], v[64:67]
    s_add_u32 s66, s58, 37888
    buffer_load_dwordx4 a[76:79], v31, s[32:35], s66 offen offset:0 sc1
    s_waitcnt lgkmcnt(14)
    ds_write_b128 v2, v[60:63] offset:15360
    v_mfma_f32_16x16x32_bf16 v[80:83], v[240:243], a[240:243], v[80:83]
    s_waitcnt lgkmcnt(14)
    ds_write_b128 v2, v[76:79] offset:16384
    v_mfma_f32_16x16x32_bf16 v[96:99], v[244:247], a[240:243], v[96:99]
    s_waitcnt lgkmcnt(14)
    ds_write_b128 v2, v[92:95] offset:17408
    v_mfma_f32_16x16x32_bf16 v[112:115], v[248:251], a[240:243], v[112:115]
    s_waitcnt lgkmcnt(14)
    ds_write_b128 v2, v[108:111] offset:18432
    v_mfma_f32_16x16x32_bf16 v[128:131], v[252:255], a[240:243], v[128:131]
    s_add_u32 s66, s58, 10240
    buffer_load_dwordx4 a[80:83], v31, s[32:35], s66 offen offset:0 sc1
    s_waitcnt lgkmcnt(14)
    ds_write_b128 v2, v[124:127] offset:19456
    s_lshl_b32 s50, s48, 2
    s_add_u32 s50, s50, s3
    s_lshl_b32 s51, s50, 5
    v_lshlrev_b32 v144, 1, v27
    v_add_u32 v144, s51, v144
    global_load_ushort v26, v144, s[20:21]
    s_nop 7
    s_waitcnt lgkmcnt(14)
    ds_write_b128 v2, v[140:143] offset:20480
    v_lshlrev_b32 v145, 4, v1
    s_sub_u32 s52, s3, 1
    s_and_b32 s52, s52, 3
    s_mul_i32 s52, s52, 24576
    s_add_u32 s52, s52, 65536
    v_add_u32 v147, s52, v145
    s_sub_u32 s52, s3, 2
    s_and_b32 s52, s52, 3
    s_mul_i32 s52, s52, 24576
    s_add_u32 s52, s52, 65536
    v_add_u32 v148, s52, v145
    s_sub_u32 s52, s3, 3
    s_and_b32 s52, s52, 3
    s_mul_i32 s52, s52, 24576
    s_add_u32 s52, s52, 65536
    v_add_u32 v149, s52, v145
    s_add_u32 s66, s58, 38912
    buffer_load_dwordx4 a[84:87], v31, s[32:35], s66 offen offset:0 sc1
    s_add_u32 s66, s58, 11264
    buffer_load_dwordx4 a[88:91], v31, s[32:35], s66 offen offset:0 sc1
    s_waitcnt lgkmcnt(0)
    s_barrier
    ds_read_b128 v[152:155], v147 offset:0
    ds_read_b128 v[156:159], v147 offset:1024
    ds_read_b128 v[160:163], v147 offset:2048
    ds_read_b128 v[164:167], v147 offset:3072
    ds_read_b128 v[168:171], v147 offset:4096
    ds_read_b128 v[172:175], v147 offset:5120
    ds_read_b128 v[176:179], v147 offset:6144
    s_add_u32 s66, s58, 39936
    buffer_load_dwordx4 a[92:95], v31, s[32:35], s66 offen offset:0 sc1
    ds_read_b128 v[180:183], v148 offset:7168
    ds_read_b128 v[184:187], v148 offset:8192
    ds_read_b128 v[188:191], v148 offset:9216
    ds_read_b128 v[192:195], v148 offset:10240
    ds_read_b128 v[196:199], v148 offset:11264
    ds_read_b128 v[200:203], v148 offset:12288
    ds_read_b128 v[204:207], v148 offset:13312
    s_add_u32 s66, s58, 12288
    buffer_load_dwordx4 a[96:99], v31, s[32:35], s66 offen offset:0 sc1
    ds_read_b128 v[208:211], v149 offset:14336
    s_waitcnt lgkmcnt(14)
    ds_read_b128 v[212:215], v149 offset:15360
    s_waitcnt lgkmcnt(14)
    ds_read_b128 v[216:219], v149 offset:16384
    s_waitcnt lgkmcnt(14)
    ds_read_b128 v[220:223], v149 offset:17408
    s_waitcnt lgkmcnt(14)
    ds_read_b128 v[224:227], v149 offset:18432
    s_waitcnt lgkmcnt(14)
    ds_read_b128 v[228:231], v149 offset:19456
    s_waitcnt lgkmcnt(14)
    ds_read_b128 v[232:235], v149 offset:20480
    s_add_u32 s66, s58, 40960
    buffer_load_dwordx4 a[100:103], v31, s[32:35], s66 offen offset:0 sc1
    s_lshl_b32 s52, s3, 12
    s_add_u32 s52, s52, 0x0
    v_lshlrev_b32 v150, 3, v1
    v_add_u32 v150, s52, v150
    s_waitcnt lgkmcnt(14)
    ds_read_b64 v[236:237], v150 offset:0
    s_waitcnt lgkmcnt(14)
    ds_read_b64 v[238:239], v150 offset:512
    s_waitcnt lgkmcnt(14)
    ds_read_b64 v[240:241], v150 offset:1024
    s_waitcnt lgkmcnt(14)
    ds_read_b64 v[242:243], v150 offset:1536
    s_waitcnt lgkmcnt(14)
    ds_read_b64 v[244:245], v150 offset:2048
    s_waitcnt lgkmcnt(14)
    ds_read_b64 v[246:247], v150 offset:2560
    s_waitcnt lgkmcnt(14)
    ds_read_b64 v[248:249], v150 offset:3072
    v_pk_add_f32 v[32:33], v[32:33], v[152:153]
    v_pk_add_f32 v[34:35], v[34:35], v[154:155]
    v_pk_add_f32 v[48:49], v[48:49], v[156:157]
    v_pk_add_f32 v[50:51], v[50:51], v[158:159]
    v_pk_add_f32 v[64:65], v[64:65], v[160:161]
    v_pk_add_f32 v[66:67], v[66:67], v[162:163]
    v_pk_add_f32 v[80:81], v[80:81], v[164:165]
    v_pk_add_f32 v[82:83], v[82:83], v[166:167]
    v_pk_add_f32 v[96:97], v[96:97], v[168:169]
    v_pk_add_f32 v[98:99], v[98:99], v[170:171]
    v_pk_add_f32 v[112:113], v[112:113], v[172:173]
    v_pk_add_f32 v[114:115], v[114:115], v[174:175]
    v_pk_add_f32 v[128:129], v[128:129], v[176:177]
    v_pk_add_f32 v[130:131], v[130:131], v[178:179]
    s_add_u32 s66, s58, 13312
    buffer_load_dwordx4 a[104:107], v31, s[32:35], s66 offen offset:0 sc1
    s_waitcnt lgkmcnt(14)
    v_pk_add_f32 v[32:33], v[32:33], v[180:181]
    v_pk_add_f32 v[34:35], v[34:35], v[182:183]
    v_pk_add_f32 v[48:49], v[48:49], v[184:185]
    v_pk_add_f32 v[50:51], v[50:51], v[186:187]
    v_pk_add_f32 v[64:65], v[64:65], v[188:189]
    v_pk_add_f32 v[66:67], v[66:67], v[190:191]
    v_pk_add_f32 v[80:81], v[80:81], v[192:193]
    v_pk_add_f32 v[82:83], v[82:83], v[194:195]
    v_pk_add_f32 v[96:97], v[96:97], v[196:197]
    v_pk_add_f32 v[98:99], v[98:99], v[198:199]
    v_pk_add_f32 v[112:113], v[112:113], v[200:201]
    v_pk_add_f32 v[114:115], v[114:115], v[202:203]
    v_pk_add_f32 v[128:129], v[128:129], v[204:205]
    v_pk_add_f32 v[130:131], v[130:131], v[206:207]
    s_add_u32 s66, s58, 41984
    buffer_load_dwordx4 a[108:111], v31, s[32:35], s66 offen offset:0 sc1
    s_waitcnt lgkmcnt(7)
    v_pk_add_f32 v[32:33], v[32:33], v[208:209]
    v_pk_add_f32 v[34:35], v[34:35], v[210:211]
    v_pk_add_f32 v[48:49], v[48:49], v[212:213]
    v_pk_add_f32 v[50:51], v[50:51], v[214:215]
    v_pk_add_f32 v[64:65], v[64:65], v[216:217]
    v_pk_add_f32 v[66:67], v[66:67], v[218:219]
    v_pk_add_f32 v[80:81], v[80:81], v[220:221]
    v_pk_add_f32 v[82:83], v[82:83], v[222:223]
    v_pk_add_f32 v[96:97], v[96:97], v[224:225]
    v_pk_add_f32 v[98:99], v[98:99], v[226:227]
    v_pk_add_f32 v[112:113], v[112:113], v[228:229]
    v_pk_add_f32 v[114:115], v[114:115], v[230:231]
    v_pk_add_f32 v[128:129], v[128:129], v[232:233]
    v_pk_add_f32 v[130:131], v[130:131], v[234:235]
    s_add_u32 s66, s58, 14336
    buffer_load_dwordx4 a[112:115], v31, s[32:35], s66 offen offset:0 sc1
    s_waitcnt lgkmcnt(0)
    s_waitcnt vmcnt(8)
    v_lshlrev_b32 v26, 16, v26
    s_lshl_b32 s50, s48, 2
    s_add_u32 s50, s50, s3
    s_mul_i32 s50, s50, 28672
    s_add_u32 s50, s50, 0xe00000
    s_mul_i32 s51, s49, 7
    s_lshr_b32 s52, s51, 1
    s_lshl_b32 s52, s52, 10
    s_add_u32 s50, s50, s52
    v_lshlrev_b32 v145, 4, v1
    v_lshlrev_b32 v146, 16, v236
    v_and_b32 v147, 0xffff0000, v236
    v_lshlrev_b32 v148, 16, v237
    v_and_b32 v149, 0xffff0000, v237
    v_add_f32 v32, v32, v26
    v_add_f32 v33, v33, v26
    v_add_f32 v34, v34, v26
    v_add_f32 v35, v35, v26
    v_pk_mul_f32 v[32:33], v[32:33], v[146:147]
    v_pk_mul_f32 v[34:35], v[34:35], v[148:149]
    v_cvt_pk_bf16_f32 v152, v32, v33
    v_cvt_pk_bf16_f32 v153, v34, v35
    v_lshlrev_b32 v146, 16, v238
    v_and_b32 v147, 0xffff0000, v238
    v_lshlrev_b32 v148, 16, v239
    v_and_b32 v149, 0xffff0000, v239
    v_add_f32 v48, v48, v26
    v_add_f32 v49, v49, v26
    v_add_f32 v50, v50, v26
    v_add_f32 v51, v51, v26
    v_pk_mul_f32 v[48:49], v[48:49], v[146:147]
    v_pk_mul_f32 v[50:51], v[50:51], v[148:149]
    v_cvt_pk_bf16_f32 v154, v48, v49
    v_cvt_pk_bf16_f32 v155, v50, v51
    v_lshlrev_b32 v146, 16, v240
    v_and_b32 v147, 0xffff0000, v240
    v_lshlrev_b32 v148, 16, v241
    v_and_b32 v149, 0xffff0000, v241
    v_add_f32 v64, v64, v26
    v_add_f32 v65, v65, v26
    v_add_f32 v66, v66, v26
    v_add_f32 v67, v67, v26
    v_pk_mul_f32 v[64:65], v[64:65], v[146:147]
    v_pk_mul_f32 v[66:67], v[66:67], v[148:149]
    v_cvt_pk_bf16_f32 v156, v64, v65
    v_cvt_pk_bf16_f32 v157, v66, v67
    v_lshlrev_b32 v146, 16, v242
    v_and_b32 v147, 0xffff0000, v242
    v_lshlrev_b32 v148, 16, v243
    v_and_b32 v149, 0xffff0000, v243
    v_add_f32 v80, v80, v26
    v_add_f32 v81, v81, v26
    v_add_f32 v82, v82, v26
    v_add_f32 v83, v83, v26
    v_pk_mul_f32 v[80:81], v[80:81], v[146:147]
    v_pk_mul_f32 v[82:83], v[82:83], v[148:149]
    v_cvt_pk_bf16_f32 v158, v80, v81
    v_cvt_pk_bf16_f32 v159, v82, v83
    v_lshlrev_b32 v146, 16, v244
    v_and_b32 v147, 0xffff0000, v244
    v_lshlrev_b32 v148, 16, v245
    v_and_b32 v149, 0xffff0000, v245
    v_add_f32 v96, v96, v26
    v_add_f32 v97, v97, v26
    v_add_f32 v98, v98, v26
    v_add_f32 v99, v99, v26
    v_pk_mul_f32 v[96:97], v[96:97], v[146:147]
    v_pk_mul_f32 v[98:99], v[98:99], v[148:149]
    v_cvt_pk_bf16_f32 v160, v96, v97
    v_cvt_pk_bf16_f32 v161, v98, v99
    v_lshlrev_b32 v146, 16, v246
    v_and_b32 v147, 0xffff0000, v246
    v_lshlrev_b32 v148, 16, v247
    v_and_b32 v149, 0xffff0000, v247
    v_add_f32 v112, v112, v26
    v_add_f32 v113, v113, v26
    v_add_f32 v114, v114, v26
    v_add_f32 v115, v115, v26
    v_pk_mul_f32 v[112:113], v[112:113], v[146:147]
    v_pk_mul_f32 v[114:115], v[114:115], v[148:149]
    v_cvt_pk_bf16_f32 v162, v112, v113
    v_cvt_pk_bf16_f32 v163, v114, v115
    v_lshlrev_b32 v146, 16, v248
    v_and_b32 v147, 0xffff0000, v248
    v_lshlrev_b32 v148, 16, v249
    v_and_b32 v149, 0xffff0000, v249
    v_add_f32 v128, v128, v26
    v_add_f32 v129, v129, v26
    v_add_f32 v130, v130, v26
    v_add_f32 v131, v131, v26
    v_pk_mul_f32 v[128:129], v[128:129], v[146:147]
    v_pk_mul_f32 v[130:131], v[130:131], v[148:149]
    v_cvt_pk_bf16_f32 v164, v128, v129
    v_cvt_pk_bf16_f32 v165, v130, v131
    s_bitcmp1_b32 s49, 0
    s_cbranch_scc1 podd_32
    buffer_store_dwordx4 v[152:155], v145, s[32:35], s50 offen offset:0 sc1
    buffer_store_dwordx4 v[156:159], v145, s[32:35], s50 offen offset:1024 sc1
    buffer_store_dwordx4 v[160:163], v145, s[32:35], s50 offen offset:2048 sc1
    buffer_store_dwordx2 v[164:165], v145, s[32:35], s50 offen offset:3072 sc1
    s_branch pdone_33
podd_32:
    buffer_store_dwordx2 v[152:153], v145, s[32:35], s50 offen offset:8 sc1
    v_mov_b32 v148, v154
    v_mov_b32 v149, v155
    v_mov_b32 v150, v156
    v_mov_b32 v151, v157
    buffer_store_dwordx4 v[148:151], v145, s[32:35], s50 offen offset:1024 sc1
    s_nop 1
    v_mov_b32 v148, v158
    v_mov_b32 v149, v159
    v_mov_b32 v150, v160
    v_mov_b32 v151, v161
    buffer_store_dwordx4 v[148:151], v145, s[32:35], s50 offen offset:2048 sc1
    s_nop 1
    v_mov_b32 v148, v162
    v_mov_b32 v149, v163
    v_mov_b32 v150, v164
    v_mov_b32 v151, v165
    buffer_store_dwordx4 v[148:151], v145, s[32:35], s50 offen offset:3072 sc1
    s_nop 1
pdone_33:
    s_add_u32 s66, s58, 43008
    buffer_load_dwordx4 a[116:119], v31, s[32:35], s66 offen offset:0 sc1
    s_add_u32 s66, s58, 15360
    buffer_load_dwordx4 a[120:123], v31, s[32:35], s66 offen offset:0 sc1
    s_add_u32 s66, s58, 44032
    buffer_load_dwordx4 a[124:127], v31, s[32:35], s66 offen offset:0 sc1
    s_add_u32 s66, s58, 16384
    buffer_load_dwordx4 a[128:131], v31, s[32:35], s66 offen offset:0 sc1
    s_add_u32 s66, s58, 45056
    buffer_load_dwordx4 a[132:135], v31, s[32:35], s66 offen offset:0 sc1
    s_add_u32 s66, s58, 17408
    buffer_load_dwordx4 a[136:139], v31, s[32:35], s66 offen offset:0 sc1
    s_add_u32 s66, s58, 46080
    buffer_load_dwordx4 a[140:143], v31, s[32:35], s66 offen offset:0 sc1
    s_add_u32 s66, s58, 18432
    buffer_load_dwordx4 a[144:147], v31, s[32:35], s66 offen offset:0 sc1
    s_add_u32 s66, s58, 47104
    buffer_load_dwordx4 a[148:151], v31, s[32:35], s66 offen offset:0 sc1
    s_add_u32 s66, s58, 19456
    buffer_load_dwordx4 a[152:155], v31, s[32:35], s66 offen offset:0 sc1
    s_add_u32 s66, s58, 48128
    buffer_load_dwordx4 a[156:159], v31, s[32:35], s66 offen offset:0 sc1
    s_add_u32 s66, s58, 20480
    buffer_load_dwordx4 a[160:163], v31, s[32:35], s66 offen offset:0 sc1
    s_add_u32 s66, s58, 49152
    buffer_load_dwordx4 a[164:167], v31, s[32:35], s66 offen offset:0 sc1
    s_add_u32 s66, s58, 21504
    buffer_load_dwordx4 a[168:171], v31, s[32:35], s66 offen offset:0 sc1
    s_waitcnt vmcnt(14)
    s_barrier
    s_cmp_eq_u32 s3, 0
    s_cbranch_scc0 arr_34
    s_lshl_b32 s50, s48, 8
    s_add_u32 s50, s50, 0x155c800
    s_mov_b64 s[52:53], exec
    s_mov_b64 exec, 1
    v_mov_b32 v29, s50
    v_mov_b32 v30, 1
    global_atomic_add v29, v30, s[28:29] sc1
    s_mov_b64 exec, s[52:53]
arr_34:
    s_add_u32 s66, s58, 50176
    buffer_load_dwordx4 a[172:175], v31, s[32:35], s66 offen offset:0 sc1
    s_add_u32 s66, s58, 22528
    buffer_load_dwordx4 a[176:179], v31, s[32:35], s66 offen offset:0 sc1
    s_add_u32 s66, s58, 51200
    buffer_load_dwordx4 a[180:183], v31, s[32:35], s66 offen offset:0 sc1
    s_add_u32 s66, s58, 23552
    buffer_load_dwordx4 a[184:187], v31, s[32:35], s66 offen offset:0 sc1
    s_add_u32 s66, s58, 52224
    buffer_load_dwordx4 a[188:191], v31, s[32:35], s66 offen offset:0 sc1
    s_add_u32 s66, s58, 24576
    buffer_load_dwordx4 a[192:195], v31, s[32:35], s66 offen offset:0 sc1
    s_add_u32 s66, s58, 53248
    buffer_load_dwordx4 a[196:199], v31, s[32:35], s66 offen offset:0 sc1
    s_add_u32 s66, s58, 25600
    buffer_load_dwordx4 a[200:203], v31, s[32:35], s66 offen offset:0 sc1
    s_add_u32 s66, s58, 54272
    buffer_load_dwordx4 a[204:207], v31, s[32:35], s66 offen offset:0 sc1
    s_add_u32 s66, s58, 26624
    buffer_load_dwordx4 a[208:211], v31, s[32:35], s66 offen offset:0 sc1
    s_add_u32 s66, s58, 55296
    buffer_load_dwordx4 a[212:215], v31, s[32:35], s66 offen offset:0 sc1
    s_add_u32 s66, s58, 27648
    buffer_load_dwordx4 a[216:219], v31, s[32:35], s66 offen offset:0 sc1
    s_add_u32 s66, s58, 56320
    buffer_load_dwordx4 a[220:223], v31, s[32:35], s66 offen offset:0 sc1
    s_cmp_eq_u32 s3, 0
    s_cbranch_scc0 pskip_35
    s_lshl_b32 s50, s48, 8
    s_add_u32 s50, s50, 0x155c800
    s_mov_b64 s[52:53], exec
    v_lshlrev_b32 v29, 8, v1
    v_add_u32 v29, s50, v29
    s_mov_b64 exec, 0x1
    s_mov_b32 s51, 0
ploop_36:
    global_load_dword v30, v29, s[28:29] sc1
    s_waitcnt vmcnt(0)
    v_cmp_gt_u32 vcc, 8, v30
    s_nop 1
    s_cmp_eq_u64 vcc, 0
    s_cbranch_scc1 pdone_37
    s_add_u32 s51, s51, 1
    s_cmp_lt_u32 s51, 0x200000
    s_cbranch_scc1 ploop_36
pdone_37:
    s_mov_b64 exec, s[52:53]
pskip_35:
    s_barrier
    v_lshlrev_b32 v240, 4, v1
    s_lshl_b32 s52, s48, 2
    s_and_b32 s50, s49, 1
    s_lshl_b32 s50, s50, 1
    s_add_u32 s52, s52, s50
    s_and_b32 s50, s3, 1
    s_add_u32 s52, s52, s50
    s_mul_i32 s52, s52, 28
    s_mul_i32 s53, s50, 28
    s_lshr_b32 s50, s3, 1
    s_add_u32 s52, s52, s50
    s_add_u32 s53, s53, s50
    s_lshl_b32 s52, s52, 10
    s_add_u32 s52, s52, 0xe00000
    s_lshl_b32 s53, s53, 10
    s_add_u32 s50, s52, 0
    s_add_u32 m0, s53, 0x0
    s_nop 0
    buffer_load_dwordx4 v240, s[32:35], s50 offen sc1 lds
    s_add_u32 s50, s52, 2048
    s_add_u32 m0, s53, 0x800
    s_nop 0
    buffer_load_dwordx4 v240, s[32:35], s50 offen sc1 lds
    s_add_u32 s50, s52, 4096
    s_add_u32 m0, s53, 0x1000
    s_nop 0
    buffer_load_dwordx4 v240, s[32:35], s50 offen sc1 lds
    s_add_u32 s50, s52, 6144
    s_add_u32 m0, s53, 0x1800
    s_nop 0
    buffer_load_dwordx4 v240, s[32:35], s50 offen sc1 lds
    s_add_u32 s50, s52, 8192
    s_add_u32 m0, s53, 0x2000
    s_nop 0
    buffer_load_dwordx4 v240, s[32:35], s50 offen sc1 lds
    s_add_u32 s50, s52, 10240
    s_add_u32 m0, s53, 0x2800
    s_nop 0
    buffer_load_dwordx4 v240, s[32:35], s50 offen sc1 lds
    s_add_u32 s50, s52, 12288
    s_add_u32 m0, s53, 0x3000
    s_nop 0
    buffer_load_dwordx4 v240, s[32:35], s50 offen sc1 lds
    s_add_u32 s50, s52, 14336
    s_add_u32 m0, s53, 0x3800
    s_nop 0
    buffer_load_dwordx4 v240, s[32:35], s50 offen sc1 lds
    s_waitcnt vmcnt(4)
    s_barrier
    ds_read_b128 v[48:51], v240 offset:0
    ds_read_b128 v[52:55], v240 offset:28672
    ds_read_b128 v[56:59], v240 offset:1024
    ds_read_b128 v[60:63], v240 offset:29696
    ds_read_b128 v[64:67], v240 offset:2048
    ds_read_b128 v[68:71], v240 offset:30720
    s_waitcnt lgkmcnt(4)
    v_mfma_f32_16x16x32_bf16 v[32:35], a[0:3], v[48:51], 0
    v_mfma_f32_16x16x32_bf16 v[36:39], a[4:7], v[48:51], 0
    ds_read_b128 v[72:75], v240 offset:3072
    v_mfma_f32_16x16x32_bf16 v[40:43], a[0:3], v[52:55], 0
    v_mfma_f32_16x16x32_bf16 v[44:47], a[4:7], v[52:55], 0
    ds_read_b128 v[76:79], v240 offset:31744
    s_add_u32 s50, s52, 16384
    s_add_u32 m0, s53, 0x4000
    s_nop 0
    buffer_load_dwordx4 v240, s[32:35], s50 offen sc1 lds
    s_waitcnt lgkmcnt(4)
    v_mfma_f32_16x16x32_bf16 v[32:35], a[8:11], v[56:59], v[32:35]
    v_mfma_f32_16x16x32_bf16 v[36:39], a[12:15], v[56:59], v[36:39]
    ds_read_b128 v[48:51], v240 offset:4096
    v_mfma_f32_16x16x32_bf16 v[40:43], a[8:11], v[60:63], v[40:43]
    v_mfma_f32_16x16x32_bf16 v[44:47], a[12:15], v[60:63], v[44:47]
    ds_read_b128 v[52:55], v240 offset:32768
    s_add_u32 s50, s52, 18432
    s_add_u32 m0, s53, 0x4800
    s_nop 0
    buffer_load_dwordx4 v240, s[32:35], s50 offen sc1 lds
    s_waitcnt lgkmcnt(4)
    v_mfma_f32_16x16x32_bf16 v[32:35], a[16:19], v[64:67], v[32:35]
    v_mfma_f32_16x16x32_bf16 v[36:39], a[20:23], v[64:67], v[36:39]
    ds_read_b128 v[56:59], v240 offset:5120
    v_mfma_f32_16x16x32_bf16 v[40:43], a[16:19], v[68:71], v[40:43]
    v_mfma_f32_16x16x32_bf16 v[44:47], a[20:23], v[68:71], v[44:47]
    ds_read_b128 v[60:63], v240 offset:33792
    s_add_u32 s50, s52, 20480
    s_add_u32 m0, s53, 0x5000
    s_nop 0
    buffer_load_dwordx4 v240, s[32:35], s50 offen sc1 lds
    s_waitcnt lgkmcnt(4)
    v_mfma_f32_16x16x32_bf16 v[32:35], a[24:27], v[72:75], v[32:35]
    v_mfma_f32_16x16x32_bf16 v[36:39], a[28:31], v[72:75], v[36:39]
    ds_read_b128 v[64:67], v240 offset:6144
    v_mfma_f32_16x16x32_bf16 v[40:43], a[24:27], v[76:79], v[40:43]
    v_mfma_f32_16x16x32_bf16 v[44:47], a[28:31], v[76:79], v[44:47]
    ds_read_b128 v[68:71], v240 offset:34816
    s_add_u32 s50, s52, 22528
    s_add_u32 m0, s53, 0x5800
    s_nop 0
    buffer_load_dwordx4 v240, s[32:35], s50 offen sc1 lds
    s_waitcnt lgkmcnt(4)
    v_mfma_f32_16x16x32_bf16 v[32:35], a[32:35], v[48:51], v[32:35]
    v_mfma_f32_16x16x32_bf16 v[36:39], a[36:39], v[48:51], v[36:39]
    ds_read_b128 v[72:75], v240 offset:7168
    v_mfma_f32_16x16x32_bf16 v[40:43], a[32:35], v[52:55], v[40:43]
    v_mfma_f32_16x16x32_bf16 v[44:47], a[36:39], v[52:55], v[44:47]
    ds_read_b128 v[76:79], v240 offset:35840
    s_add_u32 s50, s52, 24576
    s_add_u32 m0, s53, 0x6000
    s_nop 0
    buffer_load_dwordx4 v240, s[32:35], s50 offen sc1 lds
    s_waitcnt vmcnt(5)
    s_barrier
    s_waitcnt lgkmcnt(4)
    v_mfma_f32_16x16x32_bf16 v[32:35], a[40:43], v[56:59], v[32:35]
    v_mfma_f32_16x16x32_bf16 v[36:39], a[44:47], v[56:59], v[36:39]
    ds_read_b128 v[48:51], v240 offset:8192
    v_mfma_f32_16x16x32_bf16 v[40:43], a[40:43], v[60:63], v[40:43]
    v_mfma_f32_16x16x32_bf16 v[44:47], a[44:47], v[60:63], v[44:47]
    ds_read_b128 v[52:55], v240 offset:36864
    s_add_u32 s50, s52, 26624
    s_add_u32 m0, s53, 0x6800
    s_nop 0
    buffer_load_dwordx4 v240, s[32:35], s50 offen sc1 lds
    s_waitcnt lgkmcnt(4)
    v_mfma_f32_16x16x32_bf16 v[32:35], a[48:51], v[64:67], v[32:35]
    v_mfma_f32_16x16x32_bf16 v[36:39], a[52:55], v[64:67], v[36:39]
    ds_read_b128 v[56:59], v240 offset:9216
    v_mfma_f32_16x16x32_bf16 v[40:43], a[48:51], v[68:71], v[40:43]
    v_mfma_f32_16x16x32_bf16 v[44:47], a[52:55], v[68:71], v[44:47]
    ds_read_b128 v[60:63], v240 offset:37888
    s_waitcnt lgkmcnt(4)
    v_mfma_f32_16x16x32_bf16 v[32:35], a[56:59], v[72:75], v[32:35]
    v_mfma_f32_16x16x32_bf16 v[36:39], a[60:63], v[72:75], v[36:39]
    ds_read_b128 v[64:67], v240 offset:10240
    v_mfma_f32_16x16x32_bf16 v[40:43], a[56:59], v[76:79], v[40:43]
    v_mfma_f32_16x16x32_bf16 v[44:47], a[60:63], v[76:79], v[44:47]
    ds_read_b128 v[68:71], v240 offset:38912
    s_waitcnt lgkmcnt(4)
    v_mfma_f32_16x16x32_bf16 v[32:35], a[64:67], v[48:51], v[32:35]
    v_mfma_f32_16x16x32_bf16 v[36:39], a[68:71], v[48:51], v[36:39]
    ds_read_b128 v[72:75], v240 offset:11264
    v_mfma_f32_16x16x32_bf16 v[40:43], a[64:67], v[52:55], v[40:43]
    v_mfma_f32_16x16x32_bf16 v[44:47], a[68:71], v[52:55], v[44:47]
    ds_read_b128 v[76:79], v240 offset:39936
    s_waitcnt lgkmcnt(4)
    v_mfma_f32_16x16x32_bf16 v[32:35], a[72:75], v[56:59], v[32:35]
    v_mfma_f32_16x16x32_bf16 v[36:39], a[76:79], v[56:59], v[36:39]
    ds_read_b128 v[48:51], v240 offset:12288
    v_mfma_f32_16x16x32_bf16 v[40:43], a[72:75], v[60:63], v[40:43]
    v_mfma_f32_16x16x32_bf16 v[44:47], a[76:79], v[60:63], v[44:47]
    ds_read_b128 v[52:55], v240 offset:40960
    s_waitcnt lgkmcnt(4)
    v_mfma_f32_16x16x32_bf16 v[32:35], a[80:83], v[64:67], v[32:35]
    v_mfma_f32_16x16x32_bf16 v[36:39], a[84:87], v[64:67], v[36:39]
    ds_read_b128 v[56:59], v240 offset:13312
    v_mfma_f32_16x16x32_bf16 v[40:43], a[80:83], v[68:71], v[40:43]
    v_mfma_f32_16x16x32_bf16 v[44:47], a[84:87], v[68:71], v[44:47]
    ds_read_b128 v[60:63], v240 offset:41984
    s_waitcnt lgkmcnt(4)
    v_mfma_f32_16x16x32_bf16 v[32:35], a[88:91], v[72:75], v[32:35]
    v_mfma_f32_16x16x32_bf16 v[36:39], a[92:95], v[72:75], v[36:39]
    ds_read_b128 v[64:67], v240 offset:14336
    v_mfma_f32_16x16x32_bf16 v[40:43], a[88:91], v[76:79], v[40:43]
    v_mfma_f32_16x16x32_bf16 v[44:47], a[92:95], v[76:79], v[44:47]
    ds_read_b128 v[68:71], v240 offset:43008
    s_waitcnt lgkmcnt(4)
    v_mfma_f32_16x16x32_bf16 v[32:35], a[96:99], v[48:51], v[32:35]
    v_mfma_f32_16x16x32_bf16 v[36:39], a[100:103], v[48:51], v[36:39]
    ds_read_b128 v[72:75], v240 offset:15360
    v_mfma_f32_16x16x32_bf16 v[40:43], a[96:99], v[52:55], v[40:43]
    v_mfma_f32_16x16x32_bf16 v[44:47], a[100:103], v[52:55], v[44:47]
    ds_read_b128 v[76:79], v240 offset:44032
    s_waitcnt vmcnt(2)
    s_barrier
    s_waitcnt lgkmcnt(4)
    v_mfma_f32_16x16x32_bf16 v[32:35], a[104:107], v[56:59], v[32:35]
    v_mfma_f32_16x16x32_bf16 v[36:39], a[108:111], v[56:59], v[36:39]
    ds_read_b128 v[48:51], v240 offset:16384
    v_mfma_f32_16x16x32_bf16 v[40:43], a[104:107], v[60:63], v[40:43]
    v_mfma_f32_16x16x32_bf16 v[44:47], a[108:111], v[60:63], v[44:47]
    ds_read_b128 v[52:55], v240 offset:45056
    s_waitcnt lgkmcnt(4)
    v_mfma_f32_16x16x32_bf16 v[32:35], a[112:115], v[64:67], v[32:35]
    v_mfma_f32_16x16x32_bf16 v[36:39], a[116:119], v[64:67], v[36:39]
    ds_read_b128 v[56:59], v240 offset:17408
    v_mfma_f32_16x16x32_bf16 v[40:43], a[112:115], v[68:71], v[40:43]
    v_mfma_f32_16x16x32_bf16 v[44:47], a[116:119], v[68:71], v[44:47]
    ds_read_b128 v[60:63], v240 offset:46080
    s_waitcnt lgkmcnt(4)
    v_mfma_f32_16x16x32_bf16 v[32:35], a[120:123], v[72:75], v[32:35]
    v_mfma_f32_16x16x32_bf16 v[36:39], a[124:127], v[72:75], v[36:39]
    ds_read_b128 v[64:67], v240 offset:18432
    v_mfma_f32_16x16x32_bf16 v[40:43], a[120:123], v[76:79], v[40:43]
    v_mfma_f32_16x16x32_bf16 v[44:47], a[124:127], v[76:79], v[44:47]
    ds_read_b128 v[68:71], v240 offset:47104
    s_waitcnt lgkmcnt(4)
    v_mfma_f32_16x16x32_bf16 v[32:35], a[128:131], v[48:51], v[32:35]
    v_mfma_f32_16x16x32_bf16 v[36:39], a[132:135], v[48:51], v[36:39]
    ds_read_b128 v[72:75], v240 offset:19456
    v_mfma_f32_16x16x32_bf16 v[40:43], a[128:131], v[52:55], v[40:43]
    v_mfma_f32_16x16x32_bf16 v[44:47], a[132:135], v[52:55], v[44:47]
    ds_read_b128 v[76:79], v240 offset:48128
    s_waitcnt lgkmcnt(4)
    v_mfma_f32_16x16x32_bf16 v[32:35], a[136:139], v[56:59], v[32:35]
    v_mfma_f32_16x16x32_bf16 v[36:39], a[140:143], v[56:59], v[36:39]
    ds_read_b128 v[48:51], v240 offset:20480
    v_mfma_f32_16x16x32_bf16 v[40:43], a[136:139], v[60:63], v[40:43]
    v_mfma_f32_16x16x32_bf16 v[44:47], a[140:143], v[60:63], v[44:47]
    ds_read_b128 v[52:55], v240 offset:49152
    s_waitcnt lgkmcnt(4)
    v_mfma_f32_16x16x32_bf16 v[32:35], a[144:147], v[64:67], v[32:35]
    v_mfma_f32_16x16x32_bf16 v[36:39], a[148:151], v[64:67], v[36:39]
    ds_read_b128 v[56:59], v240 offset:21504
    v_mfma_f32_16x16x32_bf16 v[40:43], a[144:147], v[68:71], v[40:43]
    v_mfma_f32_16x16x32_bf16 v[44:47], a[148:151], v[68:71], v[44:47]
    ds_read_b128 v[60:63], v240 offset:50176
    s_waitcnt lgkmcnt(4)
    v_mfma_f32_16x16x32_bf16 v[32:35], a[152:155], v[72:75], v[32:35]
    v_mfma_f32_16x16x32_bf16 v[36:39], a[156:159], v[72:75], v[36:39]
    ds_read_b128 v[64:67], v240 offset:22528
    v_mfma_f32_16x16x32_bf16 v[40:43], a[152:155], v[76:79], v[40:43]
    v_mfma_f32_16x16x32_bf16 v[44:47], a[156:159], v[76:79], v[44:47]
    ds_read_b128 v[68:71], v240 offset:51200
    s_waitcnt lgkmcnt(4)
    v_mfma_f32_16x16x32_bf16 v[32:35], a[160:163], v[48:51], v[32:35]
    v_mfma_f32_16x16x32_bf16 v[36:39], a[164:167], v[48:51], v[36:39]
    ds_read_b128 v[72:75], v240 offset:23552
    v_mfma_f32_16x16x32_bf16 v[40:43], a[160:163], v[52:55], v[40:43]
    v_mfma_f32_16x16x32_bf16 v[44:47], a[164:167], v[52:55], v[44:47]
    ds_read_b128 v[76:79], v240 offset:52224
    s_waitcnt vmcnt(0)
    s_barrier
    s_waitcnt lgkmcnt(4)
    v_mfma_f32_16x16x32_bf16 v[32:35], a[168:171], v[56:59], v[32:35]
    v_mfma_f32_16x16x32_bf16 v[36:39], a[172:175], v[56:59], v[36:39]
    ds_read_b128 v[48:51], v240 offset:24576
    v_mfma_f32_16x16x32_bf16 v[40:43], a[168:171], v[60:63], v[40:43]
    v_mfma_f32_16x16x32_bf16 v[44:47], a[172:175], v[60:63], v[44:47]
    ds_read_b128 v[52:55], v240 offset:53248
    s_waitcnt lgkmcnt(4)
    v_mfma_f32_16x16x32_bf16 v[32:35], a[176:179], v[64:67], v[32:35]
    v_mfma_f32_16x16x32_bf16 v[36:39], a[180:183], v[64:67], v[36:39]
    ds_read_b128 v[56:59], v240 offset:25600
    v_mfma_f32_16x16x32_bf16 v[40:43], a[176:179], v[68:71], v[40:43]
    v_mfma_f32_16x16x32_bf16 v[44:47], a[180:183], v[68:71], v[44:47]
    ds_read_b128 v[60:63], v240 offset:54272
    s_waitcnt lgkmcnt(4)
    v_mfma_f32_16x16x32_bf16 v[32:35], a[184:187], v[72:75], v[32:35]
    v_mfma_f32_16x16x32_bf16 v[36:39], a[188:191], v[72:75], v[36:39]
    ds_read_b128 v[64:67], v240 offset:26624
    v_mfma_f32_16x16x32_bf16 v[40:43], a[184:187], v[76:79], v[40:43]
    v_mfma_f32_16x16x32_bf16 v[44:47], a[188:191], v[76:79], v[44:47]
    ds_read_b128 v[68:71], v240 offset:55296
    s_waitcnt lgkmcnt(4)
    v_mfma_f32_16x16x32_bf16 v[32:35], a[192:195], v[48:51], v[32:35]
    v_mfma_f32_16x16x32_bf16 v[36:39], a[196:199], v[48:51], v[36:39]
    ds_read_b128 v[72:75], v240 offset:27648
    v_mfma_f32_16x16x32_bf16 v[40:43], a[192:195], v[52:55], v[40:43]
    v_mfma_f32_16x16x32_bf16 v[44:47], a[196:199], v[52:55], v[44:47]
    ds_read_b128 v[76:79], v240 offset:56320
    s_waitcnt lgkmcnt(4)
    v_mfma_f32_16x16x32_bf16 v[32:35], a[200:203], v[56:59], v[32:35]
    v_mfma_f32_16x16x32_bf16 v[36:39], a[204:207], v[56:59], v[36:39]
    v_mfma_f32_16x16x32_bf16 v[40:43], a[200:203], v[60:63], v[40:43]
    v_mfma_f32_16x16x32_bf16 v[44:47], a[204:207], v[60:63], v[44:47]
    s_waitcnt lgkmcnt(2)
    v_mfma_f32_16x16x32_bf16 v[32:35], a[208:211], v[64:67], v[32:35]
    v_mfma_f32_16x16x32_bf16 v[36:39], a[212:215], v[64:67], v[36:39]
    v_mfma_f32_16x16x32_bf16 v[40:43], a[208:211], v[68:71], v[40:43]
    v_mfma_f32_16x16x32_bf16 v[44:47], a[212:215], v[68:71], v[44:47]
    s_waitcnt lgkmcnt(0)
    v_mfma_f32_16x16x32_bf16 v[32:35], a[216:219], v[72:75], v[32:35]
    v_mfma_f32_16x16x32_bf16 v[36:39], a[220:223], v[72:75], v[36:39]
    v_mfma_f32_16x16x32_bf16 v[40:43], a[216:219], v[76:79], v[40:43]
    v_mfma_f32_16x16x32_bf16 v[44:47], a[220:223], v[76:79], v[44:47]
    s_nop 7
    v_lshlrev_b32 v112, 16, v18
    v_and_b32 v113, 0xffff0000, v18
    v_lshlrev_b32 v114, 16, v19
    v_and_b32 v115, 0xffff0000, v19
    v_pk_add_f32 v[32:33], v[32:33], v[112:113]
    v_pk_add_f32 v[34:35], v[34:35], v[114:115]
    v_cvt_pk_bf16_f32 v120, v32, v33
    v_cvt_pk_bf16_f32 v121, v34, v35
    v_lshlrev_b32 v112, 16, v20
    v_and_b32 v113, 0xffff0000, v20
    v_lshlrev_b32 v114, 16, v21
    v_and_b32 v115, 0xffff0000, v21
    v_pk_add_f32 v[36:37], v[36:37], v[112:113]
    v_pk_add_f32 v[38:39], v[38:39], v[114:115]
    v_cvt_pk_bf16_f32 v122, v36, v37
    v_cvt_pk_bf16_f32 v123, v38, v39
    v_lshlrev_b32 v112, 16, v22
    v_and_b32 v113, 0xffff0000, v22
    v_lshlrev_b32 v114, 16, v23
    v_and_b32 v115, 0xffff0000, v23
    v_pk_add_f32 v[40:41], v[40:41], v[112:113]
    v_pk_add_f32 v[42:43], v[42:43], v[114:115]
    v_cvt_pk_bf16_f32 v124, v40, v41
    v_cvt_pk_bf16_f32 v125, v42, v43
    v_lshlrev_b32 v112, 16, v24
    v_and_b32 v113, 0xffff0000, v24
    v_lshlrev_b32 v114, 16, v25
    v_and_b32 v115, 0xffff0000, v25
    v_pk_add_f32 v[44:45], v[44:45], v[112:113]
    v_pk_add_f32 v[46:47], v[46:47], v[114:115]
    v_cvt_pk_bf16_f32 v126, v44, v45
    v_cvt_pk_bf16_f32 v127, v46, v47
    s_mov_b32 s36, s24
    s_mov_b32 s37, s25
    s_mov_b32 s38, 0x200000
    s_mov_b32 s39, 0x20000
    s_lshl_b32 s50, s48, 16
    s_and_b32 s51, s49, 1
    s_lshl_b32 s51, s51, 15
    s_add_u32 s50, s50, s51
    s_lshr_b32 s51, s49, 1
    s_lshl_b32 s51, s51, 8
    s_add_u32 s50, s50, s51
    s_lshl_b32 s51, s3, 6
    s_add_u32 s50, s50, s51
    v_lshlrev_b32 v240, 10, v27
    v_and_b32 v241, 1, v28
    v_lshl_add_u32 v240, v241, 5, v240
    v_lshrrev_b32 v241, 1, v28
    v_lshl_add_u32 v240, v241, 4, v240
    s_nop 1
    v_permlane16_swap_b32 v120, v122
    v_permlane16_swap_b32 v121, v123
    buffer_store_dwordx4 v[120:123], v240, s[36:39], s50 offen offset:0
    s_add_u32 s50, s50, 16384
    s_nop 1
    v_permlane16_swap_b32 v124, v126
    v_permlane16_swap_b32 v125, v127
    buffer_store_dwordx4 v[124:127], v240, s[36:39], s50 offen offset:0
KEND:
    s_endpgm

.section .rodata,"a"
.p2align 6
.amdhsa_kernel sequential_preLN__ssm_conv_h3__mixer_gmlp__prompt_kernel
  .amdhsa_next_free_vgpr 512
  .amdhsa_next_free_sgpr 102
  .amdhsa_accum_offset 256
  .amdhsa_group_segment_fixed_size 0
  .amdhsa_kernarg_size 112
  .amdhsa_user_sgpr_count 2
  .amdhsa_user_sgpr_kernarg_segment_ptr 1
  .amdhsa_system_sgpr_workgroup_id_x 1
  .amdhsa_float_denorm_mode_32 3
  .amdhsa_float_denorm_mode_16_64 3
.end_amdhsa_kernel
```
